```python
import torch

def _softmax(x, axis=-1):
    return torch.softmax(x, dim=axis)
def _gelu(x):
    return torch.nn.functional.gelu(x, approximate="tanh")
def _silu(x):
    return torch.nn.functional.silu(x)
def _sigmoid(x):
    return torch.sigmoid(x)
def _layernorm(x, axis=-1, eps=1e-5):
    m = x.mean(dim=axis, keepdim=True)
    v = x.var(dim=axis, keepdim=True, unbiased=False)
    return (x - m) / torch.sqrt(v + eps)
def _scatter_add(tgt, idx, src, axis=0):
    return tgt.clone().index_add_(axis, idx, src)
def _segment_sum(src, seg, n):
    out = torch.zeros((n,) + src.shape[1:], dtype=src.dtype)
    return out.index_add_(0, seg, src)
def _pad(x, pw):
    flat = tuple(v for pair in reversed(pw) for v in pair)
    return torch.nn.functional.pad(x, flat)

kernel_name = 'gated_mix__ssm_conv_s4__dense_activation_relu__prompt'

def setup_inputs():

    _w = (lambda a: (lambda t: t.to(torch.bfloat16) if t.is_floating_point() else t)(torch.as_tensor(a)))
    def _A_setup():
        B, L, D, N = 1, 2048, 640, 128
        A_re = -(lambda _x: torch.exp(torch.as_tensor(_x)))((lambda *s: torch.randn(*s, dtype=torch.bfloat16) * 3.2)(D, N))
        A_im = torch.pi * (lambda *s: torch.randn(*s, dtype=torch.bfloat16) * 0.2)(D, N)
        B_re = (lambda *s: torch.randn(*s, dtype=torch.bfloat16) * 0.4)(D, N)
        B_im = (lambda *s: torch.randn(*s, dtype=torch.bfloat16) * 0.4)(D, N)
        C_re = (lambda *s: torch.randn(*s, dtype=torch.bfloat16) * 0.4)(D, N)
        C_im = (lambda *s: torch.randn(*s, dtype=torch.bfloat16) * 0.4)(D, N)
        log_dt = (lambda *s: torch.randn(*s, dtype=torch.bfloat16) * 0.2)(D) * 0.5 - 4.0
        Dskip = (lambda *s: torch.randn(*s, dtype=torch.bfloat16) * 0.4)(D)
        return {
            "u": _w((lambda *s: torch.randn(*s, dtype=torch.bfloat16) * 0.05)(B, L, D)),
            "A_re": _w(A_re),
            "A_im": _w(A_im),
            "B_re": _w(B_re),
            "B_im": _w(B_im),
            "C_re": _w(C_re),
            "C_im": _w(C_im),
            "log_dt": _w(log_dt),
            "Dskip": _w(Dskip),
        }
    _A_in = _A_setup()

    def _B_setup():
        B, S, D, Dff = 1, 2048, 640, 1728
        return {
            "x": _w((lambda *s: torch.randn(*s, dtype=torch.bfloat16) * 0.05)(B, S, D)),
            "w1": _w((lambda *s: torch.randn(*s, dtype=torch.bfloat16) * 0.05)(D, Dff)),
            "w2": _w((lambda *s: torch.randn(*s, dtype=torch.bfloat16) * 0.05)(Dff, D)),
        }
    _B_in = _B_setup()

    return {
        "A_u": _A_in["u"],
        "A_A_re": _A_in["A_re"],
        "A_A_im": _A_in["A_im"],
        "A_B_re": _A_in["B_re"],
        "A_B_im": _A_in["B_im"],
        "A_C_re": _A_in["C_re"],
        "A_C_im": _A_in["C_im"],
        "A_log_dt": _A_in["log_dt"],
        "A_Dskip": _A_in["Dskip"],
        "B_x": _B_in["x"],
        "B_w1": _B_in["w1"],
        "B_w2": _B_in["w2"],
        "gate_w": _w((lambda *s: torch.randn(*s, dtype=torch.bfloat16) * 0.05)(640) * 16.0),
    }

def reference(A_u, A_A_re, A_A_im, A_B_re, A_B_im, A_C_re, A_C_im, A_log_dt, A_Dskip, B_x, B_w1, B_w2, gate_w):
    def _A_ref(u, A_re, A_im, B_re, B_im, C_re, C_im, log_dt, Dskip):
        Bsz, L, D = u.shape
        dt = torch.exp(log_dt)[:, None]
        A = A_re + 1j * A_im
        Bc = B_re + 1j * B_im
        Cc = C_re + 1j * C_im
        logdA = dt * A
        dB = dt * Bc
        l = (lambda x, dt: x.to(dt))(torch.arange(L), A_re.dtype)
        P = torch.exp(logdA[:, :, None] * l[None, None, :])
        K = torch.einsum("dn,dnl,dn->dl", Cc, P, dB).real
        L2 = 2 * L
        Kp = _pad(K, ((0, 0), (0, L)))
        up = (lambda x, *d: x.permute(*d))(u, 0, 2, 1)
        up = _pad(up, ((0, 0), (0, 0), (0, L)))
        Kf = (lambda x, axes=(-2,-1): torch.fft.rfft2(x.float(), dim=axes))(Kp[:, None, :], axes=(-2, -1))
        Uf = (lambda x, axes=(-2,-1): torch.fft.rfft2(x.float(), dim=axes))(up[:, :, None, :], axes=(-2, -1))
        Yf = Uf * Kf[None, :, :, :]
        y = (lambda x, s, axes=(-2,-1): torch.fft.irfft2(x, s=s, dim=axes).to(torch.bfloat16))(Yf, (1, L2), axes=(-2, -1))[:, :, 0, :L]
        y = (lambda x, *d: x.permute(*d))(y, 0, 2, 1) + u * Dskip[None, None, :]
        return y

    def _B_ref(x, w1, w2):
        h = torch.einsum("bsd,df->bsf", x, w1)
        zero = torch.zeros_like(h)
        h = torch.maximum(h, zero)
        return torch.einsum("bsf,fd->bsd", h, w2)

    x = A_u
    g = _sigmoid((x * gate_w).sum(-1, keepdims=True))
    a = _A_ref(x, A_A_re, A_A_im, A_B_re, A_B_im, A_C_re, A_C_im, A_log_dt, A_Dskip)
    b = _B_ref(x, B_w1, B_w2)
    return g * a + (1 - g) * b
```

```asm
; @launch grid=(256,1,1) block=(512,1,1) lds=163840
.amdgcn_target "amdgcn-amd-amdhsa--gfx950"
.text
.globl gated_mix__ssm_conv_s4__dense_activation_relu__prompt_kernel
.p2align 8
.type gated_mix__ssm_conv_s4__dense_activation_relu__prompt_kernel,@function
gated_mix__ssm_conv_s4__dense_activation_relu__prompt_kernel:
    s_load_dwordx16 s[16:31], s[0:1], 0
    s_load_dwordx16 s[32:47], s[0:1], 64
    s_cmp_ge_u32 s2, 256
    s_cbranch_scc1 L_end
    v_lshrrev_b32 v2, 6, v0
    v_and_b32 v1, 63, v0
    v_readfirstlane_b32 s3, v2
    s_cmp_lt_u32 s2, 224
    s_cbranch_scc1 L_ncp
    s_getpc_b64 s[12:13]
L_pc:
    v_lshlrev_b32 v3, 6, v0
    v_min_u32 v3, L_code_end-L_pc-4, v3
    global_load_dword v250, v3, s[12:13]
L_ncp:
    s_lshr_b32 s92, s3, 2
    s_and_b32 s3, s3, 3
    s_lshr_b32 s10, s2, 3
    s_and_b32 s11, s10, 3
    s_lshr_b32 s10, s10, 2
    s_and_b32 s7, s2, 3
    s_lshl_b32 s7, s7, 2
    s_add_u32 s7, s7, s11
    s_bfe_u32 s8, s2, 0x10002
    s_mul_i32 s8, s8, 7
    s_add_u32 s8, s8, s10
    s_lshl_b32 s101, s10, 1
    s_bfe_u32 s80, s2, 0x10002
    s_add_u32 s101, s101, s80
    s_cmp_ge_u32 s10, 5
    s_cselect_b32 s80, 3, 0
    s_add_u32 s101, s101, s80
    s_mul_i32 s80, s11, 5
    s_add_u32 s80, s80, 1
    s_lshr_b32 s80, s80, 1
    s_add_u32 s101, s101, s80
    s_cmp_ge_u32 s101, 10
    s_cselect_b32 s80, 10, 0
    s_sub_u32 s101, s101, s80
    s_cmp_ge_u32 s101, 10
    s_cselect_b32 s80, 10, 0
    s_sub_u32 s101, s101, s80
    s_lshl_b32 s80, s7, 7
    s_lshl_b32 s78, s3, 5
    s_add_u32 s80, s80, s78
    v_lshrrev_b32 v2, 3, v1
    v_add_u32 v2, s80, v2
    v_mul_u32_u24 v2, 1280, v2
    v_lshrrev_b32 v3, 4, v1
    v_xor_b32 v6, v3, v1
    v_and_b32 v6, 7, v6
    v_lshl_add_u32 v12, v6, 4, v2
    s_lshl_b32 s78, s3, 12
    s_add_u32 s78, s78, 40960
    v_xor_b32 v13, 64, v12
    v_add_u32 v13, 9216, v13
    v_add_u32 v14, 18432, v12
    v_add_u32 v15, 18432, v13
    s_lshl_b32 s80, s3, 3
    v_add_u32 v2, s80, v3
    v_mul_u32_u24 v2, 3456, v2
    s_lshl_b32 s79, s8, 8
    v_add_u32 v2, s79, v2
    v_lshlrev_b32 v16, 2, v3
    v_xor_b32 v16, v16, v1
    v_and_b32 v16, 15, v16
    v_lshl_add_u32 v16, v16, 4, v2
    v_add_u32 v17, 12800, v16
    s_lshl_b32 s79, s3, 11
    s_add_u32 s79, s79, 0
    v_mov_b32 v24, 0
    v_mov_b32 v25, 0
    v_mov_b32 v26, 0
    v_mov_b32 v27, 0
    v_mov_b32 v28, 0
    v_mov_b32 v29, 0
    s_lshl_b32 s81, s2, 2
    s_add_u32 s81, s81, s3
    s_lshl_b32 s85, s81, 1
    s_add_u32 s85, s85, s92
    s_lshl_b32 s85, s85, 7
    v_lshl_add_u32 v33, v1, 1, s85
    s_lshr_b32 s85, s81, 1
    s_lshl_b32 s85, s85, 2
    s_cmp_ge_u32 s2, 160
    s_waitcnt lgkmcnt(0)
    s_cbranch_scc1 L_nok
    global_load_short_d16_hi v24, v33, s[18:19]
    global_load_short_d16_hi v25, v33, s[20:21]
    global_load_short_d16_hi v26, v33, s[22:23]
    global_load_short_d16_hi v27, v33, s[24:25]
    global_load_short_d16_hi v28, v33, s[26:27]
    global_load_short_d16_hi v29, v33, s[28:29]
    s_load_dword s82, s[30:31], s85
    s_load_dword s83, s[32:33], s85
L_nok:
    s_mov_b32 s60, s46
    s_mov_b32 s61, s47
    s_mov_b32 s62, 0x2000000
    s_mov_b32 s63, 0x00020000
    s_mov_b32 s72, s44
    s_mov_b32 s73, s45
    s_mov_b32 s74, 0x100
    s_mov_b32 s75, 0x00020000
    s_mov_b32 s48, s16
    s_mov_b32 s49, s17
    s_mov_b32 s50, 0x280000
    s_mov_b32 s51, 0x00020000
    s_cmp_eq_u32 s92, 0
    s_cbranch_scc1 L_gh
    s_cmp_ge_u32 s2, 160
    s_cbranch_scc1 L_load
    s_xor_b32 s10, s92, 1
    s_lshl_b32 s10, s10, 2
    s_add_u32 s10, s10, s3
    s_mul_i32 s84, s10, 8704
    s_add_u32 s84, s84, 90112
    v_lshl_add_u32 v30, v1, 2, s84
    v_add_u32 v34, 0, v30
    v_add_u32 v35, 1088, v30
    v_add_u32 v36, 2176, v30
    v_add_u32 v37, 3264, v30
    v_add_u32 v38, 4352, v30
    v_add_u32 v39, 5440, v30
    v_add_u32 v40, 6528, v30
    v_add_u32 v41, 7616, v30
    v_and_b32 v2, 15, v1
    v_lshrrev_b32 v3, 4, v1
    v_lshl_add_u32 v3, v3, 4, s84
    v_mul_u32_u24 v31, 272, v2
    v_add_u32 v31, v31, v3
    v_lshrrev_b32 v42, 2, v2
    v_and_b32 v43, 1, v2
    v_lshl_add_u32 v42, v42, 1, v43
    v_add_u32 v42, 16, v42
    v_and_b32 v43, 2, v2
    v_cmp_eq_u32 vcc, 0, v43
    v_mov_b32 v43, 24
    s_nop 0
    v_cndmask_b32 v42, v43, v42, vcc
    v_mul_u32_u24 v32, 272, v42
    v_add_u32 v32, v32, v3
    s_mul_i32 s5, s3, 8704
    s_add_u32 s5, s5, 124928
    s_mul_i32 s80, s3, 2816
    s_add_u32 s80, s80, 108544
    v_mov_b32 v8, 0
    s_lshl_b32 s10, s3, 2
    s_add_u32 s10, s10, 159760
    v_mov_b32 v12, s10
    ds_write_b32 v12, v8
    v_bfe_u32 v2, v1, 2, 2
    v_sub_u32 v3, 3, v2
    v_lshrrev_b32 v233, 4, v1
    v_lshl_add_u32 v3, v233, 3, v3
    v_bfe_u32 v234, v3, 1, 3
    v_bfe_u32 v235, v1, 1, 1
    v_xor_b32 v234, v234, v235
    v_lshlrev_b32 v234, 4, v234
    v_lshl_add_u32 v234, v3, 7, v234
    v_and_b32 v235, 1, v1
    v_lshl_add_u32 v234, v235, 3, v234
    v_xor_b32 v236, 0, v234
    v_add_u32 v236, s78, v236
    v_xor_b32 v237, 32, v234
    v_add_u32 v237, s78, v237
    v_xor_b32 v238, 64, v234
    v_add_u32 v238, s78, v238
    v_xor_b32 v239, 96, v234
    v_add_u32 v239, s78, v239
    v_and_b32 v234, 3, v1
    v_xor_b32 v234, s3, v234
    v_lshlrev_b32 v234, 4, v234
    v_lshl_add_u32 v234, v233, 6, v234
    v_lshl_add_u32 v232, v2, 14, v234
    s_lshl_b32 s6, s7, 2
    s_add_u32 s6, s6, s3
    s_lshl_b32 s4, s101, 18
    s_lshl_b32 s11, s6, 8
    s_add_u32 s4, s4, s11
    s_add_u32 s4, s4, 8388608
    s_lshl_b32 s100, s101, 6
    s_add_u32 s100, s100, s6
    s_lshl_b32 s100, s100, 6
    s_add_u32 s100, s100, 16384000
    s_mov_b32 s76, 0xaaaaaaaa
    s_mov_b32 s77, 0xaaaaaaaa
    s_mov_b32 s78, 0x88888888
    s_mov_b32 s79, 0x88888888
    s_mov_b32 s12, 0xeeeeeeee
    s_mov_b32 s13, 0xeeeeeeee
    v_and_b32 v2, 15, v1
    v_lshrrev_b32 v3, 4, v1
    v_lshlrev_b32 v15, 6, v2
    v_lshl_add_u32 v15, v3, 4, v15
    v_add_u32 v15, s80, v15
    v_lshlrev_b32 v16, 5, v2
    v_lshl_add_u32 v16, v3, 4, v16
    v_lshlrev_b32 v17, 4, v2
    v_lshl_add_u32 v17, v3, 8, v17
    v_cmp_gt_u32 vcc, 32, v1
    s_nop 1
    v_cndmask_b32 v16, v17, v16, vcc
    v_add_u32 v16, s80, v16
    v_lshlrev_b32 v17, 3, v2
    v_lshl_add_u32 v17, v3, 7, v17
    v_add_u32 v17, s80, v17
    v_lshl_add_u32 v18, v1, 2, s80
    v_lshlrev_b32 v9, 4, v1
    v_lshl_add_u32 v14, v1, 4, s5
    v_lshl_add_u32 v19, v1, 4, s80
    v_lshl_add_u32 v20, v1, 3, s80
    v_lshrrev_b32 v21, 1, v1
    v_lshl_add_u32 v21, v21, 2, s80
    v_add_u32 v21, 2048, v21
    v_add_u32 v22, 1536, v18
    v_mov_b32 v23, s80
    s_waitcnt lgkmcnt(0)
    s_bitcmp1_b32 s81, 0
    s_cselect_b32 s10, 0, 16
    s_lshl_b32 s82, s82, s10
    s_and_b32 s82, s82, 0xffff0000
    s_lshl_b32 s83, s83, s10
    s_lshr_b32 s83, s83, 16
    v_mov_b32 v2, s82
    v_mul_f32 v3, 0x3fb8aa3b, v2
    s_mov_b32 s10, 0x3fb8aa3b
    v_fma_f32 v43, v2, s10, -v3
    v_fmac_f32 v43, 0x32a57060, v2
    v_exp_f32 v3, v3
    v_mul_f32 v43, 0x3f317218, v43
    v_fma_f32 v3, v3, v43, v3
    v_cvt_pk_bf16_f32 v3, v3, v3
    v_lshlrev_b32 v42, 16, v3
    v_xor_b32 v43, 0x80000000, v42
    v_mul_f32 v200, 0x3fb8aa3b, v42
    v_mul_f32 v203, 0.15915494, v42
    v_mul_f32 v201, 0x41800000, v200
    v_mul_f32 v202, 0x43800000, v200
    v_mul_f32 v204, 0x41800000, v203
    v_mul_f32 v205, 0x43800000, v203
    s_waitcnt vmcnt(0)
    s_branch L_kg
L_gh:
    s_cmp_ge_u32 s2, 224
    s_cbranch_scc1 L_p
    s_mov_b32 s52, s36
    s_mov_b32 s53, s37
    s_mov_b32 s54, 0x21c000
    s_mov_b32 s55, 0x00020000
    s_lshl_b32 s76, s101, 7
    s_mul_i32 s77, s101, 221184
    s_add_u32 s4, s2, 1
    s_and_b32 s4, s4, 3
    s_lshl_b32 s4, s4, 1
    s_bfe_u32 s5, s2, 0x10002
    s_add_u32 s4, s4, s5
    s_lshl_b32 s4, s4, 2
    s_bfe_u32 s5, s2, 0x20003
    s_add_u32 s4, s4, s5
    s_lshr_b32 s5, s2, 5
    s_mul_i32 s6, s3, 14
    s_cmp_eq_u32 s3, 3
    s_cselect_b32 s6, 41, s6
    v_mov_b32 v8, 0
    v_lshlrev_b32 v9, 4, v1
    s_cmp_ge_u32 s3, 2
    s_cselect_b32 s10, 12, 13
    v_and_b32 v2, 31, v1
    v_min_u32 v2, s10, v2
    v_add_u32 v2, s6, v2
    s_mul_i32 s10, s5, 5
    s_lshr_b32 s10, s10, 2
    v_lshrrev_b32 v3, 5, v1
    v_add_u32 v3, s10, v3
    v_lshlrev_b32 v3, 12, v3
    v_lshl_add_u32 v10, v2, 6, v3
    v_add_u32 v10, 16318464, v10
    s_lshr_b32 s80, s3, 1
    s_lshl_b32 s80, s80, 13
    s_add_u32 s80, s80, 40960
    v_and_b32 v2, 31, v1
    v_lshlrev_b32 v2, 7, v2
    v_add_u32 v2, s80, v2
    v_lshrrev_b32 v3, 5, v1
    v_bfe_u32 v6, v1, 1, 3
    v_xor_b32 v3, v3, v6
    v_lshl_add_u32 v18, v3, 4, v2
    v_xor_b32 v19, 32, v18
    v_xor_b32 v20, 64, v18
    v_xor_b32 v21, 96, v18
    v_bfe_u32 v6, v1, 2, 2
    v_lshrrev_b32 v2, 5, v1
    v_lshlrev_b32 v2, 11, v2
    v_lshl_add_u32 v2, v6, 8, v2
    s_and_b32 s80, s3, 1
    s_lshl_b32 s80, s80, 1
    v_xor_b32 v3, s80, v6
    v_lshl_add_u32 v2, v3, 6, v2
    v_bfe_u32 v3, v1, 4, 1
    v_lshl_add_u32 v2, v3, 5, v2
    v_and_b32 v3, 3, v1
    v_lshl_add_u32 v2, v3, 3, v2
    v_add_u32 v22, 0, v2
    v_xor_b32 v23, 64, v22
    s_xor_b32 s10, s92, 1
    s_lshl_b32 s10, s10, 2
    s_add_u32 s10, s10, s3
    s_mul_i32 s84, s10, 8704
    s_add_u32 s84, s84, 90112
    v_lshl_add_u32 v30, v1, 2, s84
    v_add_u32 v34, 0, v30
    v_add_u32 v35, 1088, v30
    v_add_u32 v36, 2176, v30
    v_add_u32 v37, 3264, v30
    v_add_u32 v38, 4352, v30
    v_add_u32 v39, 5440, v30
    v_add_u32 v40, 6528, v30
    v_add_u32 v41, 7616, v30
    v_and_b32 v2, 15, v1
    v_lshrrev_b32 v3, 4, v1
    v_lshl_add_u32 v3, v3, 4, s84
    v_mul_u32_u24 v31, 272, v2
    v_add_u32 v31, v31, v3
    v_lshrrev_b32 v42, 2, v2
    v_and_b32 v43, 1, v2
    v_lshl_add_u32 v42, v42, 1, v43
    v_add_u32 v42, 16, v42
    v_and_b32 v43, 2, v2
    v_cmp_eq_u32 vcc, 0, v43
    v_mov_b32 v43, 24
    s_nop 0
    v_cndmask_b32 v42, v43, v42, vcc
    v_mul_u32_u24 v32, 272, v42
    v_add_u32 v32, v32, v3
    s_waitcnt lgkmcnt(0)
    s_bitcmp1_b32 s81, 0
    s_cselect_b32 s10, 0, 16
    s_lshl_b32 s82, s82, s10
    s_and_b32 s82, s82, 0xffff0000
    s_lshl_b32 s83, s83, s10
    s_lshr_b32 s83, s83, 16
    v_mov_b32 v2, s82
    v_mul_f32 v3, 0x3fb8aa3b, v2
    s_mov_b32 s10, 0x3fb8aa3b
    v_fma_f32 v43, v2, s10, -v3
    v_fmac_f32 v43, 0x32a57060, v2
    v_exp_f32 v3, v3
    v_mul_f32 v43, 0x3f317218, v43
    v_fma_f32 v3, v3, v43, v3
    v_cvt_pk_bf16_f32 v3, v3, v3
    v_lshlrev_b32 v42, 16, v3
    v_xor_b32 v43, 0x80000000, v42
    v_mul_f32 v200, 0x3fb8aa3b, v42
    v_mul_f32 v203, 0.15915494, v42
    v_mul_f32 v201, 0x41800000, v200
    v_mul_f32 v202, 0x43800000, v200
    v_mul_f32 v204, 0x41800000, v203
    v_mul_f32 v205, 0x43800000, v203
    s_waitcnt vmcnt(0)
    s_add_u32 m0, s78, 0
    s_nop 0
    buffer_load_dwordx4 v12, s[48:51], s76 offen offset:0 lds
    buffer_load_dwordx4 v13, s[48:51], s76 offen offset:1024 lds
    s_add_u32 m0, s78, 0
    s_nop 0
    buffer_load_dwordx4 v14, s[48:51], s76 offen offset:2048 lds
    buffer_load_dwordx4 v15, s[48:51], s76 offen offset:3072 lds
    s_add_u32 m0, s79, 0
    s_nop 0
    buffer_load_dwordx4 v16, s[52:55], s77 offen offset:0 lds
    buffer_load_dwordx4 v17, s[52:55], s77 offen offset:1024 lds
    s_add_u32 m0, s79, 8192
    s_add_u32 s77, s77, 110592
    s_cmp_eq_u32 s77, 2211840
    s_cselect_b32 s77, 0, s77
    buffer_load_dwordx4 v16, s[52:55], s77 offen offset:0 lds
    buffer_load_dwordx4 v17, s[52:55], s77 offen offset:1024 lds
    s_cmp_ge_u32 s2, 160
    s_cbranch_scc1 L_gb
L_kg:
    v_mul_f32 v203, v203, v25
    v_mul_f32 v204, v204, v25
    v_mul_f32 v205, v205, v25
    v_mul_f32 v200, v200, v24
    v_mul_f32 v201, v201, v24
    v_mul_f32 v202, v202, v24
    v_fract_f32 v203, v203
    v_fract_f32 v204, v204
    v_fract_f32 v205, v205
    v_pk_mul_f32 v[96:97], v[28:29], v[26:27] op_sel:[0,0] op_sel_hi:[1,0]
    v_pk_fma_f32 v[96:97], v[28:29], v[26:27], v[96:97] op_sel:[1,1,0] op_sel_hi:[0,1,1] neg_lo:[0,1,0]
    v_exp_f32 v200, v200
    v_cos_f32 v206, v203
    v_sin_f32 v207, v203
    v_exp_f32 v201, v201
    v_cos_f32 v208, v204
    v_sin_f32 v209, v204
    v_exp_f32 v202, v202
    v_cos_f32 v210, v205
    v_sin_f32 v211, v205
    v_pk_mul_f32 v[94:95], v[96:97], v[42:43]
    v_pk_mul_f32 v[46:47], v[206:207], v[200:201] op_sel_hi:[1,0]
    v_pk_mul_f32 v[92:93], v[208:209], v[200:201] op_sel:[0,1] op_sel_hi:[1,1] neg_hi:[1,0]
    v_pk_mul_f32 v[76:77], v[210:211], v[202:203] op_sel_hi:[1,0]
    v_cvt_pk_bf16_f32 v98, v94, v95
    v_mov_b32 v102, 0x3f80
    v_pk_mul_f32 v[78:79], v[76:77], v[76:77] op_sel:[0,0] op_sel_hi:[1,0]
    v_pk_mul_f32 v[96:97], v[94:95], v[92:93] op_sel:[0,0] op_sel_hi:[1,0]
    v_cvt_pk_bf16_f32 v103, v46, v47
    v_pk_fma_f32 v[78:79], v[76:77], v[76:77], v[78:79] op_sel:[1,1,0] op_sel_hi:[0,1,1] neg_lo:[0,1,0]
    v_pk_fma_f32 v[96:97], v[94:95], v[92:93], v[96:97] op_sel:[1,1,0] op_sel_hi:[0,1,1] neg_lo:[0,1,0]
    ds_write2_b32 v38, v102, v103 offset0:0 offset1:68
    v_pk_mul_f32 v[80:81], v[76:77], v[78:79] op_sel:[0,0] op_sel_hi:[1,0]
    v_cvt_pk_bf16_f32 v99, v96, v97
    v_pk_mul_f32 v[48:49], v[46:47], v[46:47] op_sel:[0,0] op_sel_hi:[1,0]
    v_pk_fma_f32 v[80:81], v[76:77], v[78:79], v[80:81] op_sel:[1,1,0] op_sel_hi:[0,1,1] neg_lo:[0,1,0]
    ds_write2_b32 v34, v98, v99 offset0:0 offset1:68
    v_pk_fma_f32 v[48:49], v[46:47], v[46:47], v[48:49] op_sel:[1,1,0] op_sel_hi:[0,1,1] neg_lo:[0,1,0]
    v_pk_mul_f32 v[82:83], v[78:79], v[78:79] op_sel:[0,0] op_sel_hi:[1,0]
    v_pk_mul_f32 v[94:95], v[96:97], v[92:93] op_sel:[0,0] op_sel_hi:[1,0]
    v_cvt_pk_bf16_f32 v104, v48, v49
    v_pk_fma_f32 v[82:83], v[78:79], v[78:79], v[82:83] op_sel:[1,1,0] op_sel_hi:[0,1,1] neg_lo:[0,1,0]
    v_pk_fma_f32 v[94:95], v[96:97], v[92:93], v[94:95] op_sel:[1,1,0] op_sel_hi:[0,1,1] neg_lo:[0,1,0]
    v_pk_mul_f32 v[50:51], v[46:47], v[48:49] op_sel:[0,0] op_sel_hi:[1,0]
    v_pk_mul_f32 v[84:85], v[78:79], v[80:81] op_sel:[0,0] op_sel_hi:[1,0]
    v_cvt_pk_bf16_f32 v100, v94, v95
    v_pk_fma_f32 v[50:51], v[46:47], v[48:49], v[50:51] op_sel:[1,1,0] op_sel_hi:[0,1,1] neg_lo:[0,1,0]
    v_pk_fma_f32 v[84:85], v[78:79], v[80:81], v[84:85] op_sel:[1,1,0] op_sel_hi:[0,1,1] neg_lo:[0,1,0]
    v_pk_mul_f32 v[96:97], v[94:95], v[92:93] op_sel:[0,0] op_sel_hi:[1,0]
    v_cvt_pk_bf16_f32 v105, v50, v51
    v_pk_mul_f32 v[86:87], v[80:81], v[80:81] op_sel:[0,0] op_sel_hi:[1,0]
    v_pk_fma_f32 v[96:97], v[94:95], v[92:93], v[96:97] op_sel:[1,1,0] op_sel_hi:[0,1,1] neg_lo:[0,1,0]
    ds_write2_b32 v38, v104, v105 offset0:136 offset1:204
    v_pk_fma_f32 v[86:87], v[80:81], v[80:81], v[86:87] op_sel:[1,1,0] op_sel_hi:[0,1,1] neg_lo:[0,1,0]
    v_cvt_pk_bf16_f32 v101, v96, v97
    v_pk_mul_f32 v[52:53], v[48:49], v[48:49] op_sel:[0,0] op_sel_hi:[1,0]
    v_pk_mul_f32 v[88:89], v[80:81], v[82:83] op_sel:[0,0] op_sel_hi:[1,0]
    ds_write2_b32 v34, v100, v101 offset0:136 offset1:204
    v_pk_fma_f32 v[52:53], v[48:49], v[48:49], v[52:53] op_sel:[1,1,0] op_sel_hi:[0,1,1] neg_lo:[0,1,0]
    v_pk_fma_f32 v[88:89], v[80:81], v[82:83], v[88:89] op_sel:[1,1,0] op_sel_hi:[0,1,1] neg_lo:[0,1,0]
    v_pk_mul_f32 v[94:95], v[96:97], v[92:93] op_sel:[0,0] op_sel_hi:[1,0]
    v_cvt_pk_bf16_f32 v102, v52, v53
    v_pk_mul_f32 v[90:91], v[82:83], v[82:83] op_sel:[0,0] op_sel_hi:[1,0]
    v_pk_fma_f32 v[94:95], v[96:97], v[92:93], v[94:95] op_sel:[1,1,0] op_sel_hi:[0,1,1] neg_lo:[0,1,0]
    v_pk_mul_f32 v[54:55], v[48:49], v[50:51] op_sel:[0,0] op_sel_hi:[1,0]
    v_pk_fma_f32 v[90:91], v[82:83], v[82:83], v[90:91] op_sel:[1,1,0] op_sel_hi:[0,1,1] neg_lo:[0,1,0]
    v_cvt_pk_bf16_f32 v98, v94, v95
    v_pk_fma_f32 v[54:55], v[48:49], v[50:51], v[54:55] op_sel:[1,1,0] op_sel_hi:[0,1,1] neg_lo:[0,1,0]
    v_pk_mul_f32 v[96:97], v[94:95], v[92:93] op_sel:[0,0] op_sel_hi:[1,0]
    v_cvt_pk_bf16_f32 v103, v54, v55
    v_pk_fma_f32 v[96:97], v[94:95], v[92:93], v[96:97] op_sel:[1,1,0] op_sel_hi:[0,1,1] neg_lo:[0,1,0]
    ds_write2_b32 v39, v102, v103 offset0:0 offset1:68
    v_cvt_pk_bf16_f32 v99, v96, v97
    v_pk_mul_f32 v[56:57], v[50:51], v[50:51] op_sel:[0,0] op_sel_hi:[1,0]
    ds_write2_b32 v35, v98, v99 offset0:0 offset1:68
    v_pk_fma_f32 v[56:57], v[50:51], v[50:51], v[56:57] op_sel:[1,1,0] op_sel_hi:[0,1,1] neg_lo:[0,1,0]
    v_pk_mul_f32 v[94:95], v[96:97], v[92:93] op_sel:[0,0] op_sel_hi:[1,0]
    v_cvt_pk_bf16_f32 v104, v56, v57
    v_pk_fma_f32 v[94:95], v[96:97], v[92:93], v[94:95] op_sel:[1,1,0] op_sel_hi:[0,1,1] neg_lo:[0,1,0]
    v_pk_mul_f32 v[58:59], v[50:51], v[52:53] op_sel:[0,0] op_sel_hi:[1,0]
    v_cvt_pk_bf16_f32 v100, v94, v95
    v_pk_fma_f32 v[58:59], v[50:51], v[52:53], v[58:59] op_sel:[1,1,0] op_sel_hi:[0,1,1] neg_lo:[0,1,0]
    v_pk_mul_f32 v[96:97], v[94:95], v[92:93] op_sel:[0,0] op_sel_hi:[1,0]
    v_cvt_pk_bf16_f32 v105, v58, v59
    v_pk_fma_f32 v[96:97], v[94:95], v[92:93], v[96:97] op_sel:[1,1,0] op_sel_hi:[0,1,1] neg_lo:[0,1,0]
    ds_write2_b32 v39, v104, v105 offset0:136 offset1:204
    v_cvt_pk_bf16_f32 v101, v96, v97
    v_pk_mul_f32 v[60:61], v[52:53], v[52:53] op_sel:[0,0] op_sel_hi:[1,0]
    ds_write2_b32 v35, v100, v101 offset0:136 offset1:204
    v_pk_fma_f32 v[60:61], v[52:53], v[52:53], v[60:61] op_sel:[1,1,0] op_sel_hi:[0,1,1] neg_lo:[0,1,0]
    v_pk_mul_f32 v[94:95], v[96:97], v[92:93] op_sel:[0,0] op_sel_hi:[1,0]
    v_cvt_pk_bf16_f32 v102, v60, v61
    v_pk_fma_f32 v[94:95], v[96:97], v[92:93], v[94:95] op_sel:[1,1,0] op_sel_hi:[0,1,1] neg_lo:[0,1,0]
    v_pk_mul_f32 v[62:63], v[52:53], v[54:55] op_sel:[0,0] op_sel_hi:[1,0]
    v_cvt_pk_bf16_f32 v98, v94, v95
    v_pk_fma_f32 v[62:63], v[52:53], v[54:55], v[62:63] op_sel:[1,1,0] op_sel_hi:[0,1,1] neg_lo:[0,1,0]
    v_pk_mul_f32 v[96:97], v[94:95], v[92:93] op_sel:[0,0] op_sel_hi:[1,0]
    v_cvt_pk_bf16_f32 v103, v62, v63
    v_pk_fma_f32 v[96:97], v[94:95], v[92:93], v[96:97] op_sel:[1,1,0] op_sel_hi:[0,1,1] neg_lo:[0,1,0]
    ds_write2_b32 v40, v102, v103 offset0:0 offset1:68
    v_cvt_pk_bf16_f32 v99, v96, v97
    v_pk_mul_f32 v[64:65], v[54:55], v[54:55] op_sel:[0,0] op_sel_hi:[1,0]
    ds_write2_b32 v36, v98, v99 offset0:0 offset1:68
    v_pk_fma_f32 v[64:65], v[54:55], v[54:55], v[64:65] op_sel:[1,1,0] op_sel_hi:[0,1,1] neg_lo:[0,1,0]
    v_pk_mul_f32 v[94:95], v[96:97], v[92:93] op_sel:[0,0] op_sel_hi:[1,0]
    v_cvt_pk_bf16_f32 v104, v64, v65
    v_pk_fma_f32 v[94:95], v[96:97], v[92:93], v[94:95] op_sel:[1,1,0] op_sel_hi:[0,1,1] neg_lo:[0,1,0]
    v_pk_mul_f32 v[66:67], v[54:55], v[56:57] op_sel:[0,0] op_sel_hi:[1,0]
    v_cvt_pk_bf16_f32 v100, v94, v95
    v_pk_fma_f32 v[66:67], v[54:55], v[56:57], v[66:67] op_sel:[1,1,0] op_sel_hi:[0,1,1] neg_lo:[0,1,0]
    v_pk_mul_f32 v[96:97], v[94:95], v[92:93] op_sel:[0,0] op_sel_hi:[1,0]
    v_cvt_pk_bf16_f32 v105, v66, v67
    v_pk_fma_f32 v[96:97], v[94:95], v[92:93], v[96:97] op_sel:[1,1,0] op_sel_hi:[0,1,1] neg_lo:[0,1,0]
    ds_write2_b32 v40, v104, v105 offset0:136 offset1:204
    v_cvt_pk_bf16_f32 v101, v96, v97
    v_pk_mul_f32 v[68:69], v[56:57], v[56:57] op_sel:[0,0] op_sel_hi:[1,0]
    ds_write2_b32 v36, v100, v101 offset0:136 offset1:204
    v_pk_fma_f32 v[68:69], v[56:57], v[56:57], v[68:69] op_sel:[1,1,0] op_sel_hi:[0,1,1] neg_lo:[0,1,0]
    v_pk_mul_f32 v[94:95], v[96:97], v[92:93] op_sel:[0,0] op_sel_hi:[1,0]
    v_cvt_pk_bf16_f32 v102, v68, v69
    v_pk_fma_f32 v[94:95], v[96:97], v[92:93], v[94:95] op_sel:[1,1,0] op_sel_hi:[0,1,1] neg_lo:[0,1,0]
    v_pk_mul_f32 v[70:71], v[56:57], v[58:59] op_sel:[0,0] op_sel_hi:[1,0]
    v_cvt_pk_bf16_f32 v98, v94, v95
    v_pk_fma_f32 v[70:71], v[56:57], v[58:59], v[70:71] op_sel:[1,1,0] op_sel_hi:[0,1,1] neg_lo:[0,1,0]
    v_pk_mul_f32 v[96:97], v[94:95], v[92:93] op_sel:[0,0] op_sel_hi:[1,0]
    v_cvt_pk_bf16_f32 v103, v70, v71
    v_pk_fma_f32 v[96:97], v[94:95], v[92:93], v[96:97] op_sel:[1,1,0] op_sel_hi:[0,1,1] neg_lo:[0,1,0]
    ds_write2_b32 v41, v102, v103 offset0:0 offset1:68
    v_cvt_pk_bf16_f32 v99, v96, v97
    v_pk_mul_f32 v[72:73], v[58:59], v[58:59] op_sel:[0,0] op_sel_hi:[1,0]
    ds_write2_b32 v37, v98, v99 offset0:0 offset1:68
    v_pk_fma_f32 v[72:73], v[58:59], v[58:59], v[72:73] op_sel:[1,1,0] op_sel_hi:[0,1,1] neg_lo:[0,1,0]
    v_pk_mul_f32 v[94:95], v[96:97], v[92:93] op_sel:[0,0] op_sel_hi:[1,0]
    v_cvt_pk_bf16_f32 v104, v72, v73
    v_pk_fma_f32 v[94:95], v[96:97], v[92:93], v[94:95] op_sel:[1,1,0] op_sel_hi:[0,1,1] neg_lo:[0,1,0]
    v_pk_mul_f32 v[74:75], v[58:59], v[60:61] op_sel:[0,0] op_sel_hi:[1,0]
    v_cvt_pk_bf16_f32 v100, v94, v95
    v_pk_fma_f32 v[74:75], v[58:59], v[60:61], v[74:75] op_sel:[1,1,0] op_sel_hi:[0,1,1] neg_lo:[0,1,0]
    v_pk_mul_f32 v[96:97], v[94:95], v[92:93] op_sel:[0,0] op_sel_hi:[1,0]
    v_cvt_pk_bf16_f32 v105, v74, v75
    v_pk_fma_f32 v[96:97], v[94:95], v[92:93], v[96:97] op_sel:[1,1,0] op_sel_hi:[0,1,1] neg_lo:[0,1,0]
    ds_write2_b32 v41, v104, v105 offset0:136 offset1:204
    v_cvt_pk_bf16_f32 v101, v96, v97
    ds_write2_b32 v37, v100, v101 offset0:136 offset1:204
    ds_read_b128 v[136:139], v31 offset:0
    ds_read_b128 v[140:143], v31 offset:4352
    ds_read_b128 v[152:155], v31 offset:64
    ds_read_b128 v[156:159], v31 offset:4416
    ds_read_b128 v[168:171], v31 offset:128
    ds_read_b128 v[172:175], v31 offset:4480
    ds_read_b128 v[184:187], v31 offset:192
    ds_read_b128 v[188:191], v31 offset:4544
    v_cvt_pk_bf16_f32 v98, v76, v77
    v_pk_mul_f32 v[116:117], v[76:77], v[60:61] op_sel:[0,0] op_sel_hi:[1,0]
    v_cvt_pk_bf16_f32 v106, v78, v79
    v_cvt_pk_bf16_f32 v110, v80, v81
    v_pk_mul_f32 v[114:115], v[76:77], v[48:49] op_sel:[0,0] op_sel_hi:[1,0]
    v_pk_fma_f32 v[116:117], v[76:77], v[60:61], v[116:117] op_sel:[1,1,0] op_sel_hi:[0,1,1] neg_lo:[0,1,0]
    v_pk_mul_f32 v[118:119], v[78:79], v[52:53] op_sel:[0,0] op_sel_hi:[1,0]
    v_pk_mul_f32 v[120:121], v[80:81], v[52:53] op_sel:[0,0] op_sel_hi:[1,0]
    v_pk_fma_f32 v[114:115], v[76:77], v[48:49], v[114:115] op_sel:[1,1,0] op_sel_hi:[0,1,1] neg_lo:[0,1,0]
    v_cvt_pk_bf16_f32 v102, v116, v117
    v_pk_fma_f32 v[118:119], v[78:79], v[52:53], v[118:119] op_sel:[1,1,0] op_sel_hi:[0,1,1] neg_lo:[0,1,0]
    v_pk_fma_f32 v[120:121], v[80:81], v[52:53], v[120:121] op_sel:[1,1,0] op_sel_hi:[0,1,1] neg_lo:[0,1,0]
    v_cvt_pk_bf16_f32 v99, v114, v115
    v_pk_mul_f32 v[116:117], v[76:77], v[64:65] op_sel:[0,0] op_sel_hi:[1,0]
    v_cvt_pk_bf16_f32 v107, v118, v119
    v_cvt_pk_bf16_f32 v111, v120, v121
    ds_write2_b32 v34, v98, v99 offset0:0 offset1:68
    v_pk_fma_f32 v[116:117], v[76:77], v[64:65], v[116:117] op_sel:[1,1,0] op_sel_hi:[0,1,1] neg_lo:[0,1,0]
    ds_write2_b32 v36, v106, v107 offset0:0 offset1:68
    ds_write2_b32 v37, v110, v111 offset0:0 offset1:68
    v_pk_mul_f32 v[114:115], v[76:77], v[52:53] op_sel:[0,0] op_sel_hi:[1,0]
    v_cvt_pk_bf16_f32 v103, v116, v117
    v_pk_mul_f32 v[118:119], v[78:79], v[60:61] op_sel:[0,0] op_sel_hi:[1,0]
    v_pk_mul_f32 v[120:121], v[80:81], v[60:61] op_sel:[0,0] op_sel_hi:[1,0]
    v_pk_fma_f32 v[114:115], v[76:77], v[52:53], v[114:115] op_sel:[1,1,0] op_sel_hi:[0,1,1] neg_lo:[0,1,0]
    ds_write2_b32 v35, v102, v103 offset0:0 offset1:68
    v_pk_fma_f32 v[118:119], v[78:79], v[60:61], v[118:119] op_sel:[1,1,0] op_sel_hi:[0,1,1] neg_lo:[0,1,0]
    v_pk_fma_f32 v[120:121], v[80:81], v[60:61], v[120:121] op_sel:[1,1,0] op_sel_hi:[0,1,1] neg_lo:[0,1,0]
    v_cvt_pk_bf16_f32 v100, v114, v115
    v_pk_mul_f32 v[116:117], v[76:77], v[68:69] op_sel:[0,0] op_sel_hi:[1,0]
    v_cvt_pk_bf16_f32 v108, v118, v119
    v_cvt_pk_bf16_f32 v112, v120, v121
    v_pk_mul_f32 v[114:115], v[76:77], v[56:57] op_sel:[0,0] op_sel_hi:[1,0]
    v_pk_fma_f32 v[116:117], v[76:77], v[68:69], v[116:117] op_sel:[1,1,0] op_sel_hi:[0,1,1] neg_lo:[0,1,0]
    v_pk_mul_f32 v[118:119], v[78:79], v[68:69] op_sel:[0,0] op_sel_hi:[1,0]
    v_pk_mul_f32 v[120:121], v[80:81], v[68:69] op_sel:[0,0] op_sel_hi:[1,0]
    v_pk_fma_f32 v[114:115], v[76:77], v[56:57], v[114:115] op_sel:[1,1,0] op_sel_hi:[0,1,1] neg_lo:[0,1,0]
    v_cvt_pk_bf16_f32 v104, v116, v117
    v_pk_fma_f32 v[118:119], v[78:79], v[68:69], v[118:119] op_sel:[1,1,0] op_sel_hi:[0,1,1] neg_lo:[0,1,0]
    v_pk_fma_f32 v[120:121], v[80:81], v[68:69], v[120:121] op_sel:[1,1,0] op_sel_hi:[0,1,1] neg_lo:[0,1,0]
    v_cvt_pk_bf16_f32 v101, v114, v115
    v_pk_mul_f32 v[116:117], v[76:77], v[72:73] op_sel:[0,0] op_sel_hi:[1,0]
    v_cvt_pk_bf16_f32 v109, v118, v119
    v_cvt_pk_bf16_f32 v113, v120, v121
    ds_write2_b32 v34, v100, v101 offset0:136 offset1:204
    v_pk_fma_f32 v[116:117], v[76:77], v[72:73], v[116:117] op_sel:[1,1,0] op_sel_hi:[0,1,1] neg_lo:[0,1,0]
    ds_write2_b32 v36, v108, v109 offset0:136 offset1:204
    ds_write2_b32 v37, v112, v113 offset0:136 offset1:204
    v_cvt_pk_bf16_f32 v98, v82, v83
    v_cvt_pk_bf16_f32 v105, v116, v117
    v_cvt_pk_bf16_f32 v106, v86, v87
    v_cvt_pk_bf16_f32 v110, v88, v89
    v_pk_mul_f32 v[114:115], v[82:83], v[60:61] op_sel:[0,0] op_sel_hi:[1,0]
    ds_write2_b32 v35, v104, v105 offset0:136 offset1:204
    v_pk_mul_f32 v[118:119], v[86:87], v[60:61] op_sel:[0,0] op_sel_hi:[1,0]
    v_pk_mul_f32 v[120:121], v[88:89], v[60:61] op_sel:[0,0] op_sel_hi:[1,0]
    v_pk_fma_f32 v[114:115], v[82:83], v[60:61], v[114:115] op_sel:[1,1,0] op_sel_hi:[0,1,1] neg_lo:[0,1,0]
    v_cvt_pk_bf16_f32 v102, v84, v85
    v_pk_fma_f32 v[118:119], v[86:87], v[60:61], v[118:119] op_sel:[1,1,0] op_sel_hi:[0,1,1] neg_lo:[0,1,0]
    v_pk_fma_f32 v[120:121], v[88:89], v[60:61], v[120:121] op_sel:[1,1,0] op_sel_hi:[0,1,1] neg_lo:[0,1,0]
    v_cvt_pk_bf16_f32 v99, v114, v115
    v_pk_mul_f32 v[116:117], v[84:85], v[60:61] op_sel:[0,0] op_sel_hi:[1,0]
    v_cvt_pk_bf16_f32 v107, v118, v119
    v_cvt_pk_bf16_f32 v111, v120, v121
    ds_write2_b32 v38, v98, v99 offset0:0 offset1:68
    v_pk_fma_f32 v[116:117], v[84:85], v[60:61], v[116:117] op_sel:[1,1,0] op_sel_hi:[0,1,1] neg_lo:[0,1,0]
    ds_write2_b32 v39, v106, v107 offset0:0 offset1:68
    ds_write2_b32 v39, v110, v111 offset0:136 offset1:204
    v_cvt_pk_bf16_f32 v100, v90, v91
    v_cvt_pk_bf16_f32 v103, v116, v117
    ds_write_b32 v30, v100 offset:6528
    ds_write2_b32 v38, v102, v103 offset0:136 offset1:204
    ds_read_b128 v[144:147], v31 offset:0
    ds_read_b128 v[148:151], v32 offset:0
    ds_read_b128 v[160:163], v31 offset:64
    ds_read_b128 v[164:167], v32 offset:64
    ds_read_b128 v[176:179], v31 offset:128
    ds_read_b128 v[180:183], v32 offset:128
    ds_read_b128 v[192:195], v31 offset:192
    ds_read_b128 v[196:199], v32 offset:192
    s_cmp_lg_u32 s92, 0
    s_cbranch_scc1 L_mid
    s_add_u32 m0, s79, 16384
    s_add_u32 s77, s77, 110592
    s_cmp_eq_u32 s77, 2211840
    s_cselect_b32 s77, 0, s77
    buffer_load_dwordx4 v16, s[52:55], s77 offen offset:0 lds
    buffer_load_dwordx4 v17, s[52:55], s77 offen offset:1024 lds
    s_add_u32 m0, s79, 24576
    s_add_u32 s77, s77, 110592
    s_cmp_eq_u32 s77, 2211840
    s_cselect_b32 s77, 0, s77
    buffer_load_dwordx4 v16, s[52:55], s77 offen offset:0 lds
    buffer_load_dwordx4 v17, s[52:55], s77 offen offset:1024 lds
    s_add_u32 m0, s78, 16384
    s_add_u32 s76, s76, 128
    s_cmp_eq_u32 s76, 1280
    s_cselect_b32 s76, 0, s76
    buffer_load_dwordx4 v12, s[48:51], s76 offen offset:0 lds
    buffer_load_dwordx4 v13, s[48:51], s76 offen offset:1024 lds
    s_add_u32 m0, s78, 16384
    s_nop 0
    buffer_load_dwordx4 v14, s[48:51], s76 offen offset:2048 lds
    buffer_load_dwordx4 v15, s[48:51], s76 offen offset:3072 lds
L_mid:
    s_waitcnt lgkmcnt(15)
    v_mfma_f32_16x16x32_bf16 v[124:127], v[140:143], v[136:139], 0
    v_mfma_f32_16x16x32_bf16 v[124:127], v[156:159], v[152:155], v[124:127]
    v_mfma_f32_16x16x32_bf16 v[124:127], v[172:175], v[168:171], v[124:127]
    v_mfma_f32_16x16x32_bf16 v[124:127], v[188:191], v[184:187], v[124:127]
    s_waitcnt lgkmcnt(6)
    v_mfma_f32_16x16x32_bf16 v[128:131], v[144:147], v[136:139], 0
    v_mfma_f32_16x16x32_bf16 v[132:135], v[148:151], v[136:139], 0
    s_waitcnt lgkmcnt(4)
    v_mfma_f32_16x16x32_bf16 v[128:131], v[160:163], v[152:155], v[128:131]
    v_mfma_f32_16x16x32_bf16 v[132:135], v[164:167], v[152:155], v[132:135]
    s_waitcnt lgkmcnt(2)
    v_mfma_f32_16x16x32_bf16 v[128:131], v[176:179], v[168:171], v[128:131]
    v_mfma_f32_16x16x32_bf16 v[132:135], v[180:183], v[168:171], v[132:135]
    s_waitcnt lgkmcnt(0)
    v_mfma_f32_16x16x32_bf16 v[128:131], v[192:195], v[184:187], v[128:131]
    v_mfma_f32_16x16x32_bf16 v[132:135], v[196:199], v[184:187], v[132:135]
    s_cmp_lg_u32 s92, 0
    s_cbranch_scc1 L_s
    v_lshl_add_u32 v2, v1, 4, s84
    s_nop 6
    ds_write_b128 v2, v[124:127] offset:0
    ds_write_b128 v2, v[128:131] offset:1024
    ds_write_b128 v2, v[132:135] offset:2048
    s_branch L_gc
L_gb:
    s_waitcnt vmcnt(0)
L_gd:
    s_add_u32 m0, s79, 16384
    s_add_u32 s77, s77, 110592
    s_cmp_eq_u32 s77, 2211840
    s_cselect_b32 s77, 0, s77
    buffer_load_dwordx4 v16, s[52:55], s77 offen offset:0 lds
    buffer_load_dwordx4 v17, s[52:55], s77 offen offset:1024 lds
    s_add_u32 m0, s79, 24576
    s_add_u32 s77, s77, 110592
    s_cmp_eq_u32 s77, 2211840
    s_cselect_b32 s77, 0, s77
    buffer_load_dwordx4 v16, s[52:55], s77 offen offset:0 lds
    buffer_load_dwordx4 v17, s[52:55], s77 offen offset:1024 lds
    s_add_u32 m0, s78, 16384
    s_add_u32 s76, s76, 128
    s_cmp_eq_u32 s76, 1280
    s_cselect_b32 s76, 0, s76
    buffer_load_dwordx4 v12, s[48:51], s76 offen offset:0 lds
    buffer_load_dwordx4 v13, s[48:51], s76 offen offset:1024 lds
    s_add_u32 m0, s78, 16384
    s_nop 0
    buffer_load_dwordx4 v14, s[48:51], s76 offen offset:2048 lds
    buffer_load_dwordx4 v15, s[48:51], s76 offen offset:3072 lds
L_gc:
L_g1:
    s_setprio 2
    s_and_b32 s80, s3, 1
    s_lshl_b32 s12, s8, 1
    s_add_u32 s80, s80, s12
    s_lshr_b32 s12, s3, 1
    s_lshl_b32 s13, s7, 1
    s_add_u32 s12, s12, s13
    s_lshl_b32 s9, s12, 5
    s_add_u32 s9, s9, s80
    s_lshl_b32 s9, s9, 6
    s_add_u32 s9, s9, 16580608
    s_mul_i32 s12, s12, 27
    s_add_u32 s12, s12, s80
    s_lshl_b32 s12, s12, 13
    s_add_u32 s13, s12, 4096
    s_cmp_lt_u32 s80, 27
    s_cselect_b32 s10, 0, 0x7f000000
    v_lshrrev_b32 v3, 5, v1
    v_lshl_add_u32 v3, v3, 8, s10
    v_and_b32 v2, 15, v1
    v_lshl_add_u32 v3, v2, 4, v3
    v_bfe_u32 v2, v1, 4, 1
    s_lshl_b32 s10, s80, 1
    s_add_u32 s10, s10, 0
    s_mov_b32 s11, 4
    s_cmp_lt_u32 s10, 41
    s_addc_u32 s11, s11, 0
    s_cmp_lt_u32 s10, 28
    s_addc_u32 s11, s11, 0
    s_cmp_lt_u32 s10, 14
    s_addc_u32 s11, s11, 0
    v_add_u32 v152, s11, v2
    v_and_b32 v152, 3, v152
    v_lshl_add_u32 v152, v152, 10, v3
    v_xor_b32 v153, 2048, v152
    s_lshl_b32 s10, s80, 1
    s_add_u32 s10, s10, 1
    s_mov_b32 s11, 4
    s_cmp_lt_u32 s10, 41
    s_addc_u32 s11, s11, 0
    s_cmp_lt_u32 s10, 28
    s_addc_u32 s11, s11, 0
    s_cmp_lt_u32 s10, 14
    s_addc_u32 s11, s11, 0
    v_add_u32 v154, s11, v2
    v_and_b32 v154, 3, v154
    v_lshl_add_u32 v154, v154, 10, v3
    v_xor_b32 v155, 2048, v154
    s_waitcnt vmcnt(10) lgkmcnt(0)
    s_barrier
    ds_read_b64_tr_b16 v[24:25], v22 offset:0
    ds_read_b64_tr_b16 v[26:27], v22 offset:1024
    ds_read_b128 v[32:35], v18 offset:0
    s_add_u32 m0, s79, 32768
    s_add_u32 s77, s77, 110592
    s_cmp_eq_u32 s77, 2211840
    s_cselect_b32 s77, 0, s77
    buffer_load_dwordx4 v16, s[52:55], s77 offen offset:0 lds
    ds_read_b64_tr_b16 v[28:29], v23 offset:0
    ds_read_b64_tr_b16 v[30:31], v23 offset:1024
    ds_read_b128 v[36:39], v18 offset:4096
    buffer_load_dwordx4 v17, s[52:55], s77 offen offset:1024 lds
    ds_read_b64_tr_b16 v[40:41], v22 offset:4096
    ds_read_b64_tr_b16 v[42:43], v22 offset:5120
    ds_read_b128 v[48:51], v19 offset:0
    ds_read_b64_tr_b16 v[44:45], v23 offset:4096
    ds_read_b64_tr_b16 v[46:47], v23 offset:5120
    ds_read_b128 v[52:55], v19 offset:4096
    s_add_u32 m0, s78, 32768
    s_add_u32 s76, s76, 128
    s_cmp_eq_u32 s76, 1280
    s_cselect_b32 s76, 0, s76
    buffer_load_dwordx4 v12, s[48:51], s76 offen offset:0 lds
    buffer_load_dwordx4 v13, s[48:51], s76 offen offset:1024 lds
    s_add_u32 m0, s78, 32768
    s_nop 0
    buffer_load_dwordx4 v14, s[48:51], s76 offen offset:2048 lds
    buffer_load_dwordx4 v15, s[48:51], s76 offen offset:3072 lds
    s_waitcnt vmcnt(14) lgkmcnt(0)
    s_barrier
    v_mfma_f32_32x32x16_bf16 v[88:103], v[24:27], v[32:35], 0
    ds_read_b64_tr_b16 v[56:57], v22 offset:8192
    ds_read_b64_tr_b16 v[58:59], v22 offset:9216
    ds_read_b128 v[64:67], v20 offset:0
    s_add_u32 m0, s78, 49152
    s_add_u32 s76, s76, 128
    s_cmp_eq_u32 s76, 1280
    s_cselect_b32 s76, 0, s76
    buffer_load_dwordx4 v12, s[48:51], s76 offen offset:0 lds
    v_mfma_f32_32x32x16_bf16 v[120:135], v[28:31], v[32:35], 0
    ds_read_b64_tr_b16 v[60:61], v23 offset:8192
    ds_read_b64_tr_b16 v[62:63], v23 offset:9216
    ds_read_b128 v[68:71], v20 offset:4096
    buffer_load_dwordx4 v13, s[48:51], s76 offen offset:1024 lds
    v_mfma_f32_32x32x16_bf16 v[104:119], v[24:27], v[36:39], 0
    ds_read_b64_tr_b16 v[72:73], v22 offset:12288
    ds_read_b64_tr_b16 v[74:75], v22 offset:13312
    ds_read_b128 v[80:83], v21 offset:0
    v_mfma_f32_32x32x16_bf16 v[136:151], v[28:31], v[36:39], 0
    ds_read_b64_tr_b16 v[76:77], v23 offset:12288
    ds_read_b64_tr_b16 v[78:79], v23 offset:13312
    ds_read_b128 v[84:87], v21 offset:4096
    s_add_u32 m0, s79, 0
    s_add_u32 s77, s77, 110592
    s_cmp_eq_u32 s77, 2211840
    s_cselect_b32 s77, 0, s77
    buffer_load_dwordx4 v16, s[52:55], s77 offen offset:0 lds
    v_mfma_f32_32x32x16_bf16 v[88:103], v[40:43], v[48:51], v[88:103]
    buffer_load_dwordx4 v17, s[52:55], s77 offen offset:1024 lds
    v_mfma_f32_32x32x16_bf16 v[120:135], v[44:47], v[48:51], v[120:135]
    s_add_u32 m0, s78, 49152
    s_nop 0
    buffer_load_dwordx4 v14, s[48:51], s76 offen offset:2048 lds
    v_mfma_f32_32x32x16_bf16 v[104:119], v[40:43], v[52:55], v[104:119]
    buffer_load_dwordx4 v15, s[48:51], s76 offen offset:3072 lds
    v_mfma_f32_32x32x16_bf16 v[136:151], v[44:47], v[52:55], v[136:151]
    s_waitcnt vmcnt(12) lgkmcnt(0)
    s_barrier
    v_mfma_f32_32x32x16_bf16 v[88:103], v[56:59], v[64:67], v[88:103]
    ds_read_b64_tr_b16 v[24:25], v22 offset:16384
    ds_read_b64_tr_b16 v[26:27], v22 offset:17408
    ds_read_b128 v[32:35], v18 offset:16384
    v_mfma_f32_32x32x16_bf16 v[120:135], v[60:63], v[64:67], v[120:135]
    ds_read_b64_tr_b16 v[28:29], v23 offset:16384
    ds_read_b64_tr_b16 v[30:31], v23 offset:17408
    ds_read_b128 v[36:39], v18 offset:20480
    s_add_u32 m0, s79, 8192
    s_add_u32 s77, s77, 110592
    s_cmp_eq_u32 s77, 2211840
    s_cselect_b32 s77, 0, s77
    buffer_load_dwordx4 v16, s[52:55], s77 offen offset:0 lds
    v_mfma_f32_32x32x16_bf16 v[104:119], v[56:59], v[68:71], v[104:119]
    ds_read_b64_tr_b16 v[40:41], v22 offset:20480
    ds_read_b64_tr_b16 v[42:43], v22 offset:21504
    ds_read_b128 v[48:51], v19 offset:16384
    v_mfma_f32_32x32x16_bf16 v[136:151], v[60:63], v[68:71], v[136:151]
    ds_read_b64_tr_b16 v[44:45], v23 offset:20480
    ds_read_b64_tr_b16 v[46:47], v23 offset:21504
    ds_read_b128 v[52:55], v19 offset:20480
    buffer_load_dwordx4 v17, s[52:55], s77 offen offset:1024 lds
    v_mfma_f32_32x32x16_bf16 v[88:103], v[72:75], v[80:83], v[88:103]
    v_mfma_f32_32x32x16_bf16 v[120:135], v[76:79], v[80:83], v[120:135]
    s_add_u32 m0, s78, 0
    s_add_u32 s76, s76, 128
    s_cmp_eq_u32 s76, 1280
    s_cselect_b32 s76, 0, s76
    buffer_load_dwordx4 v12, s[48:51], s76 offen offset:0 lds
    v_mfma_f32_32x32x16_bf16 v[104:119], v[72:75], v[84:87], v[104:119]
    buffer_load_dwordx4 v13, s[48:51], s76 offen offset:1024 lds
    v_mfma_f32_32x32x16_bf16 v[136:151], v[76:79], v[84:87], v[136:151]
    s_waitcnt lgkmcnt(0)
    s_barrier
    v_mfma_f32_32x32x16_bf16 v[88:103], v[24:27], v[32:35], v[88:103]
    ds_read_b64_tr_b16 v[56:57], v22 offset:24576
    ds_read_b64_tr_b16 v[58:59], v22 offset:25600
    ds_read_b128 v[64:67], v20 offset:16384
    v_mfma_f32_32x32x16_bf16 v[120:135], v[28:31], v[32:35], v[120:135]
    ds_read_b64_tr_b16 v[60:61], v23 offset:24576
    ds_read_b64_tr_b16 v[62:63], v23 offset:25600
    ds_read_b128 v[68:71], v20 offset:20480
    s_add_u32 m0, s79, 16384
    s_add_u32 s77, s77, 110592
    s_cmp_eq_u32 s77, 2211840
    s_cselect_b32 s77, 0, s77
    buffer_load_dwordx4 v16, s[52:55], s77 offen offset:0 lds
    v_mfma_f32_32x32x16_bf16 v[104:119], v[24:27], v[36:39], v[104:119]
    ds_read_b64_tr_b16 v[72:73], v22 offset:28672
    ds_read_b64_tr_b16 v[74:75], v22 offset:29696
    ds_read_b128 v[80:83], v21 offset:16384
    v_mfma_f32_32x32x16_bf16 v[136:151], v[28:31], v[36:39], v[136:151]
    ds_read_b64_tr_b16 v[76:77], v23 offset:28672
    ds_read_b64_tr_b16 v[78:79], v23 offset:29696
    ds_read_b128 v[84:87], v21 offset:20480
    buffer_load_dwordx4 v17, s[52:55], s77 offen offset:1024 lds
    v_mfma_f32_32x32x16_bf16 v[88:103], v[40:43], v[48:51], v[88:103]
    v_mfma_f32_32x32x16_bf16 v[120:135], v[44:47], v[48:51], v[120:135]
    s_add_u32 m0, s78, 0
    s_nop 0
    buffer_load_dwordx4 v14, s[48:51], s76 offen offset:2048 lds
    v_mfma_f32_32x32x16_bf16 v[104:119], v[40:43], v[52:55], v[104:119]
    buffer_load_dwordx4 v15, s[48:51], s76 offen offset:3072 lds
    v_mfma_f32_32x32x16_bf16 v[136:151], v[44:47], v[52:55], v[136:151]
    s_waitcnt vmcnt(14) lgkmcnt(0)
    s_barrier
    v_mfma_f32_32x32x16_bf16 v[88:103], v[56:59], v[64:67], v[88:103]
    ds_read_b64_tr_b16 v[24:25], v22 offset:32768
    ds_read_b64_tr_b16 v[26:27], v22 offset:33792
    ds_read_b128 v[32:35], v18 offset:32768
    v_mfma_f32_32x32x16_bf16 v[120:135], v[60:63], v[64:67], v[120:135]
    ds_read_b64_tr_b16 v[28:29], v23 offset:32768
    ds_read_b64_tr_b16 v[30:31], v23 offset:33792
    ds_read_b128 v[36:39], v18 offset:36864
    s_add_u32 m0, s79, 24576
    s_add_u32 s77, s77, 110592
    s_cmp_eq_u32 s77, 2211840
    s_cselect_b32 s77, 0, s77
    buffer_load_dwordx4 v16, s[52:55], s77 offen offset:0 lds
    v_mfma_f32_32x32x16_bf16 v[104:119], v[56:59], v[68:71], v[104:119]
    ds_read_b64_tr_b16 v[40:41], v22 offset:36864
    ds_read_b64_tr_b16 v[42:43], v22 offset:37888
    ds_read_b128 v[48:51], v19 offset:32768
    v_mfma_f32_32x32x16_bf16 v[136:151], v[60:63], v[68:71], v[136:151]
    ds_read_b64_tr_b16 v[44:45], v23 offset:36864
    ds_read_b64_tr_b16 v[46:47], v23 offset:37888
    ds_read_b128 v[52:55], v19 offset:36864
    buffer_load_dwordx4 v17, s[52:55], s77 offen offset:1024 lds
    v_mfma_f32_32x32x16_bf16 v[88:103], v[72:75], v[80:83], v[88:103]
    v_mfma_f32_32x32x16_bf16 v[120:135], v[76:79], v[80:83], v[120:135]
    s_add_u32 m0, s78, 16384
    s_add_u32 s76, s76, 128
    s_cmp_eq_u32 s76, 1280
    s_cselect_b32 s76, 0, s76
    buffer_load_dwordx4 v12, s[48:51], s76 offen offset:0 lds
    v_mfma_f32_32x32x16_bf16 v[104:119], v[72:75], v[84:87], v[104:119]
    buffer_load_dwordx4 v13, s[48:51], s76 offen offset:1024 lds
    v_mfma_f32_32x32x16_bf16 v[136:151], v[76:79], v[84:87], v[136:151]
    s_waitcnt vmcnt(14) lgkmcnt(0)
    s_barrier
    v_mfma_f32_32x32x16_bf16 v[88:103], v[24:27], v[32:35], v[88:103]
    ds_read_b64_tr_b16 v[56:57], v22 offset:0
    ds_read_b64_tr_b16 v[58:59], v22 offset:1024
    ds_read_b128 v[64:67], v20 offset:32768
    v_mfma_f32_32x32x16_bf16 v[120:135], v[28:31], v[32:35], v[120:135]
    ds_read_b64_tr_b16 v[60:61], v23 offset:0
    ds_read_b64_tr_b16 v[62:63], v23 offset:1024
    ds_read_b128 v[68:71], v20 offset:36864
    s_add_u32 m0, s79, 32768
    s_add_u32 s77, s77, 110592
    s_cmp_eq_u32 s77, 2211840
    s_cselect_b32 s77, 0, s77
    buffer_load_dwordx4 v16, s[52:55], s77 offen offset:0 lds
    v_mfma_f32_32x32x16_bf16 v[104:119], v[24:27], v[36:39], v[104:119]
    ds_read_b64_tr_b16 v[72:73], v22 offset:4096
    ds_read_b64_tr_b16 v[74:75], v22 offset:5120
    ds_read_b128 v[80:83], v21 offset:32768
    v_mfma_f32_32x32x16_bf16 v[136:151], v[28:31], v[36:39], v[136:151]
    ds_read_b64_tr_b16 v[76:77], v23 offset:4096
    ds_read_b64_tr_b16 v[78:79], v23 offset:5120
    ds_read_b128 v[84:87], v21 offset:36864
    buffer_load_dwordx4 v17, s[52:55], s77 offen offset:1024 lds
    v_mfma_f32_32x32x16_bf16 v[88:103], v[40:43], v[48:51], v[88:103]
    v_mfma_f32_32x32x16_bf16 v[120:135], v[44:47], v[48:51], v[120:135]
    s_add_u32 m0, s78, 16384
    s_nop 0
    buffer_load_dwordx4 v14, s[48:51], s76 offen offset:2048 lds
    v_mfma_f32_32x32x16_bf16 v[104:119], v[40:43], v[52:55], v[104:119]
    buffer_load_dwordx4 v15, s[48:51], s76 offen offset:3072 lds
    v_mfma_f32_32x32x16_bf16 v[136:151], v[44:47], v[52:55], v[136:151]
    s_waitcnt vmcnt(14) lgkmcnt(0)
    s_barrier
    v_mfma_f32_32x32x16_bf16 v[88:103], v[56:59], v[64:67], v[88:103]
    ds_read_b64_tr_b16 v[24:25], v22 offset:8192
    ds_read_b64_tr_b16 v[26:27], v22 offset:9216
    ds_read_b128 v[32:35], v18 offset:49152
    v_mfma_f32_32x32x16_bf16 v[120:135], v[60:63], v[64:67], v[120:135]
    ds_read_b64_tr_b16 v[28:29], v23 offset:8192
    ds_read_b64_tr_b16 v[30:31], v23 offset:9216
    ds_read_b128 v[36:39], v18 offset:53248
    s_add_u32 m0, s79, 0
    s_add_u32 s77, s77, 110592
    s_cmp_eq_u32 s77, 2211840
    s_cselect_b32 s77, 0, s77
    buffer_load_dwordx4 v16, s[52:55], s77 offen offset:0 lds
    v_mfma_f32_32x32x16_bf16 v[104:119], v[56:59], v[68:71], v[104:119]
    ds_read_b64_tr_b16 v[40:41], v22 offset:12288
    ds_read_b64_tr_b16 v[42:43], v22 offset:13312
    ds_read_b128 v[48:51], v19 offset:49152
    v_mfma_f32_32x32x16_bf16 v[136:151], v[60:63], v[68:71], v[136:151]
    ds_read_b64_tr_b16 v[44:45], v23 offset:12288
    ds_read_b64_tr_b16 v[46:47], v23 offset:13312
    ds_read_b128 v[52:55], v19 offset:53248
    buffer_load_dwordx4 v17, s[52:55], s77 offen offset:1024 lds
    v_mfma_f32_32x32x16_bf16 v[88:103], v[72:75], v[80:83], v[88:103]
    v_mfma_f32_32x32x16_bf16 v[120:135], v[76:79], v[80:83], v[120:135]
    s_add_u32 m0, s78, 32768
    s_add_u32 s76, s76, 128
    s_cmp_eq_u32 s76, 1280
    s_cselect_b32 s76, 0, s76
    buffer_load_dwordx4 v12, s[48:51], s76 offen offset:0 lds
    v_mfma_f32_32x32x16_bf16 v[104:119], v[72:75], v[84:87], v[104:119]
    buffer_load_dwordx4 v13, s[48:51], s76 offen offset:1024 lds
    v_mfma_f32_32x32x16_bf16 v[136:151], v[76:79], v[84:87], v[136:151]
    s_waitcnt vmcnt(14) lgkmcnt(0)
    s_barrier
    v_mfma_f32_32x32x16_bf16 v[88:103], v[24:27], v[32:35], v[88:103]
    ds_read_b64_tr_b16 v[56:57], v22 offset:16384
    ds_read_b64_tr_b16 v[58:59], v22 offset:17408
    ds_read_b128 v[64:67], v20 offset:49152
    v_mfma_f32_32x32x16_bf16 v[120:135], v[28:31], v[32:35], v[120:135]
    ds_read_b64_tr_b16 v[60:61], v23 offset:16384
    ds_read_b64_tr_b16 v[62:63], v23 offset:17408
    ds_read_b128 v[68:71], v20 offset:53248
    s_add_u32 m0, s79, 8192
    s_add_u32 s77, s77, 110592
    s_cmp_eq_u32 s77, 2211840
    s_cselect_b32 s77, 0, s77
    buffer_load_dwordx4 v16, s[52:55], s77 offen offset:0 lds
    v_mfma_f32_32x32x16_bf16 v[104:119], v[24:27], v[36:39], v[104:119]
    ds_read_b64_tr_b16 v[72:73], v22 offset:20480
    ds_read_b64_tr_b16 v[74:75], v22 offset:21504
    ds_read_b128 v[80:83], v21 offset:49152
    v_mfma_f32_32x32x16_bf16 v[136:151], v[28:31], v[36:39], v[136:151]
    ds_read_b64_tr_b16 v[76:77], v23 offset:20480
    ds_read_b64_tr_b16 v[78:79], v23 offset:21504
    ds_read_b128 v[84:87], v21 offset:53248
    buffer_load_dwordx4 v17, s[52:55], s77 offen offset:1024 lds
    v_mfma_f32_32x32x16_bf16 v[88:103], v[40:43], v[48:51], v[88:103]
    v_mfma_f32_32x32x16_bf16 v[120:135], v[44:47], v[48:51], v[120:135]
    s_add_u32 m0, s78, 32768
    s_nop 0
    buffer_load_dwordx4 v14, s[48:51], s76 offen offset:2048 lds
    v_mfma_f32_32x32x16_bf16 v[104:119], v[40:43], v[52:55], v[104:119]
    buffer_load_dwordx4 v15, s[48:51], s76 offen offset:3072 lds
    v_mfma_f32_32x32x16_bf16 v[136:151], v[44:47], v[52:55], v[136:151]
    buffer_load_dwordx2 v[4:5], v8, s[72:75], 0 offen sc1
    s_waitcnt vmcnt(15) lgkmcnt(0)
    s_barrier
    v_mfma_f32_32x32x16_bf16 v[88:103], v[56:59], v[64:67], v[88:103]
    ds_read_b64_tr_b16 v[24:25], v22 offset:24576
    ds_read_b64_tr_b16 v[26:27], v22 offset:25600
    ds_read_b128 v[32:35], v18 offset:0
    v_mfma_f32_32x32x16_bf16 v[120:135], v[60:63], v[64:67], v[120:135]
    ds_read_b64_tr_b16 v[28:29], v23 offset:24576
    ds_read_b64_tr_b16 v[30:31], v23 offset:25600
    ds_read_b128 v[36:39], v18 offset:4096
    s_add_u32 m0, s79, 16384
    s_add_u32 s77, s77, 110592
    s_cmp_eq_u32 s77, 2211840
    s_cselect_b32 s77, 0, s77
    buffer_load_dwordx4 v16, s[52:55], s77 offen offset:0 lds
    v_mfma_f32_32x32x16_bf16 v[104:119], v[56:59], v[68:71], v[104:119]
    ds_read_b64_tr_b16 v[40:41], v22 offset:28672
    ds_read_b64_tr_b16 v[42:43], v22 offset:29696
    ds_read_b128 v[48:51], v19 offset:0
    v_mfma_f32_32x32x16_bf16 v[136:151], v[60:63], v[68:71], v[136:151]
    ds_read_b64_tr_b16 v[44:45], v23 offset:28672
    ds_read_b64_tr_b16 v[46:47], v23 offset:29696
    ds_read_b128 v[52:55], v19 offset:4096
    buffer_load_dwordx4 v17, s[52:55], s77 offen offset:1024 lds
    v_mfma_f32_32x32x16_bf16 v[88:103], v[72:75], v[80:83], v[88:103]
    v_mfma_f32_32x32x16_bf16 v[120:135], v[76:79], v[80:83], v[120:135]
    s_add_u32 m0, s78, 49152
    s_add_u32 s76, s76, 128
    s_cmp_eq_u32 s76, 1280
    s_cselect_b32 s76, 0, s76
    buffer_load_dwordx4 v12, s[48:51], s76 offen offset:0 lds
    v_mfma_f32_32x32x16_bf16 v[104:119], v[72:75], v[84:87], v[104:119]
    buffer_load_dwordx4 v13, s[48:51], s76 offen offset:1024 lds
    v_mfma_f32_32x32x16_bf16 v[136:151], v[76:79], v[84:87], v[136:151]
    s_waitcnt vmcnt(15) lgkmcnt(0)
    s_barrier
    v_mfma_f32_32x32x16_bf16 v[88:103], v[24:27], v[32:35], v[88:103]
    ds_read_b64_tr_b16 v[56:57], v22 offset:32768
    ds_read_b64_tr_b16 v[58:59], v22 offset:33792
    ds_read_b128 v[64:67], v20 offset:0
    v_mfma_f32_32x32x16_bf16 v[120:135], v[28:31], v[32:35], v[120:135]
    ds_read_b64_tr_b16 v[60:61], v23 offset:32768
    ds_read_b64_tr_b16 v[62:63], v23 offset:33792
    ds_read_b128 v[68:71], v20 offset:4096
    s_add_u32 m0, s79, 24576
    s_add_u32 s77, s77, 110592
    s_cmp_eq_u32 s77, 2211840
    s_cselect_b32 s77, 0, s77
    buffer_load_dwordx4 v16, s[52:55], s77 offen offset:0 lds
    v_mfma_f32_32x32x16_bf16 v[104:119], v[24:27], v[36:39], v[104:119]
    ds_read_b64_tr_b16 v[72:73], v22 offset:36864
    ds_read_b64_tr_b16 v[74:75], v22 offset:37888
    ds_read_b128 v[80:83], v21 offset:0
    v_mfma_f32_32x32x16_bf16 v[136:151], v[28:31], v[36:39], v[136:151]
    ds_read_b64_tr_b16 v[76:77], v23 offset:36864
    ds_read_b64_tr_b16 v[78:79], v23 offset:37888
    ds_read_b128 v[84:87], v21 offset:4096
    buffer_load_dwordx4 v17, s[52:55], s77 offen offset:1024 lds
    v_mfma_f32_32x32x16_bf16 v[88:103], v[40:43], v[48:51], v[88:103]
    v_mfma_f32_32x32x16_bf16 v[120:135], v[44:47], v[48:51], v[120:135]
    s_add_u32 m0, s78, 49152
    s_nop 0
    buffer_load_dwordx4 v14, s[48:51], s76 offen offset:2048 lds
    v_mfma_f32_32x32x16_bf16 v[104:119], v[40:43], v[52:55], v[104:119]
    buffer_load_dwordx4 v15, s[48:51], s76 offen offset:3072 lds
    v_mfma_f32_32x32x16_bf16 v[136:151], v[44:47], v[52:55], v[136:151]
    s_waitcnt vmcnt(15) lgkmcnt(0)
    s_barrier
    v_mfma_f32_32x32x16_bf16 v[88:103], v[56:59], v[64:67], v[88:103]
    ds_read_b64_tr_b16 v[24:25], v22 offset:0
    ds_read_b64_tr_b16 v[26:27], v22 offset:1024
    ds_read_b128 v[32:35], v18 offset:16384
    v_mfma_f32_32x32x16_bf16 v[120:135], v[60:63], v[64:67], v[120:135]
    ds_read_b64_tr_b16 v[28:29], v23 offset:0
    ds_read_b64_tr_b16 v[30:31], v23 offset:1024
    ds_read_b128 v[36:39], v18 offset:20480
    s_add_u32 m0, s79, 32768
    s_add_u32 s77, s77, 110592
    s_cmp_eq_u32 s77, 2211840
    s_cselect_b32 s77, 0, s77
    buffer_load_dwordx4 v16, s[52:55], s77 offen offset:0 lds
    v_mfma_f32_32x32x16_bf16 v[104:119], v[56:59], v[68:71], v[104:119]
    ds_read_b64_tr_b16 v[40:41], v22 offset:4096
    ds_read_b64_tr_b16 v[42:43], v22 offset:5120
    ds_read_b128 v[48:51], v19 offset:16384
    v_mfma_f32_32x32x16_bf16 v[136:151], v[60:63], v[68:71], v[136:151]
    ds_read_b64_tr_b16 v[44:45], v23 offset:4096
    ds_read_b64_tr_b16 v[46:47], v23 offset:5120
    ds_read_b128 v[52:55], v19 offset:20480
    buffer_load_dwordx4 v17, s[52:55], s77 offen offset:1024 lds
    v_mfma_f32_32x32x16_bf16 v[88:103], v[72:75], v[80:83], v[88:103]
    v_mfma_f32_32x32x16_bf16 v[120:135], v[76:79], v[80:83], v[120:135]
    s_add_u32 m0, s78, 0
    s_add_u32 s76, s76, 128
    s_cmp_eq_u32 s76, 1280
    s_cselect_b32 s76, 0, s76
    buffer_load_dwordx4 v12, s[48:51], s76 offen offset:0 lds
    v_mfma_f32_32x32x16_bf16 v[104:119], v[72:75], v[84:87], v[104:119]
    buffer_load_dwordx4 v13, s[48:51], s76 offen offset:1024 lds
    v_mfma_f32_32x32x16_bf16 v[136:151], v[76:79], v[84:87], v[136:151]
    s_waitcnt vmcnt(15) lgkmcnt(0)
    s_barrier
    v_mfma_f32_32x32x16_bf16 v[88:103], v[24:27], v[32:35], v[88:103]
    ds_read_b64_tr_b16 v[56:57], v22 offset:8192
    ds_read_b64_tr_b16 v[58:59], v22 offset:9216
    ds_read_b128 v[64:67], v20 offset:16384
    v_mfma_f32_32x32x16_bf16 v[120:135], v[28:31], v[32:35], v[120:135]
    ds_read_b64_tr_b16 v[60:61], v23 offset:8192
    ds_read_b64_tr_b16 v[62:63], v23 offset:9216
    ds_read_b128 v[68:71], v20 offset:20480
    s_add_u32 m0, s79, 0
    s_add_u32 s77, s77, 110592
    s_cmp_eq_u32 s77, 2211840
    s_cselect_b32 s77, 0, s77
    buffer_load_dwordx4 v16, s[52:55], s77 offen offset:0 lds
    v_mfma_f32_32x32x16_bf16 v[104:119], v[24:27], v[36:39], v[104:119]
    ds_read_b64_tr_b16 v[72:73], v22 offset:12288
    ds_read_b64_tr_b16 v[74:75], v22 offset:13312
    ds_read_b128 v[80:83], v21 offset:16384
    v_mfma_f32_32x32x16_bf16 v[136:151], v[28:31], v[36:39], v[136:151]
    ds_read_b64_tr_b16 v[76:77], v23 offset:12288
    ds_read_b64_tr_b16 v[78:79], v23 offset:13312
    ds_read_b128 v[84:87], v21 offset:20480
    buffer_load_dwordx4 v17, s[52:55], s77 offen offset:1024 lds
    v_mfma_f32_32x32x16_bf16 v[88:103], v[40:43], v[48:51], v[88:103]
    v_mfma_f32_32x32x16_bf16 v[120:135], v[44:47], v[48:51], v[120:135]
    s_add_u32 m0, s78, 0
    s_nop 0
    buffer_load_dwordx4 v14, s[48:51], s76 offen offset:2048 lds
    v_mfma_f32_32x32x16_bf16 v[104:119], v[40:43], v[52:55], v[104:119]
    buffer_load_dwordx4 v15, s[48:51], s76 offen offset:3072 lds
    v_mfma_f32_32x32x16_bf16 v[136:151], v[44:47], v[52:55], v[136:151]
    buffer_load_dwordx2 v[6:7], v10, s[60:63], 0 offen sc1
    s_waitcnt vmcnt(15) lgkmcnt(0)
    s_barrier
    v_mfma_f32_32x32x16_bf16 v[88:103], v[56:59], v[64:67], v[88:103]
    ds_read_b64_tr_b16 v[24:25], v22 offset:16384
    ds_read_b64_tr_b16 v[26:27], v22 offset:17408
    ds_read_b128 v[32:35], v18 offset:32768
    v_mfma_f32_32x32x16_bf16 v[120:135], v[60:63], v[64:67], v[120:135]
    ds_read_b64_tr_b16 v[28:29], v23 offset:16384
    ds_read_b64_tr_b16 v[30:31], v23 offset:17408
    ds_read_b128 v[36:39], v18 offset:36864
    s_add_u32 m0, s79, 8192
    s_add_u32 s77, s77, 110592
    s_cmp_eq_u32 s77, 2211840
    s_cselect_b32 s77, 0, s77
    buffer_load_dwordx4 v16, s[52:55], s77 offen offset:0 lds
    v_mfma_f32_32x32x16_bf16 v[104:119], v[56:59], v[68:71], v[104:119]
    ds_read_b64_tr_b16 v[40:41], v22 offset:20480
    ds_read_b64_tr_b16 v[42:43], v22 offset:21504
    ds_read_b128 v[48:51], v19 offset:32768
    v_mfma_f32_32x32x16_bf16 v[136:151], v[60:63], v[68:71], v[136:151]
    ds_read_b64_tr_b16 v[44:45], v23 offset:20480
    ds_read_b64_tr_b16 v[46:47], v23 offset:21504
    ds_read_b128 v[52:55], v19 offset:36864
    buffer_load_dwordx4 v17, s[52:55], s77 offen offset:1024 lds
    v_mfma_f32_32x32x16_bf16 v[88:103], v[72:75], v[80:83], v[88:103]
    v_mfma_f32_32x32x16_bf16 v[120:135], v[76:79], v[80:83], v[120:135]
    s_add_u32 m0, s78, 16384
    s_add_u32 s76, s76, 128
    s_cmp_eq_u32 s76, 1280
    s_cselect_b32 s76, 0, s76
    buffer_load_dwordx4 v12, s[48:51], s76 offen offset:0 lds
    v_mfma_f32_32x32x16_bf16 v[104:119], v[72:75], v[84:87], v[104:119]
    buffer_load_dwordx4 v13, s[48:51], s76 offen offset:1024 lds
    v_mfma_f32_32x32x16_bf16 v[136:151], v[76:79], v[84:87], v[136:151]
    s_waitcnt vmcnt(15) lgkmcnt(0)
    s_barrier
    v_mfma_f32_32x32x16_bf16 v[88:103], v[24:27], v[32:35], v[88:103]
    ds_read_b64_tr_b16 v[56:57], v22 offset:24576
    ds_read_b64_tr_b16 v[58:59], v22 offset:25600
    ds_read_b128 v[64:67], v20 offset:32768
    v_mfma_f32_32x32x16_bf16 v[120:135], v[28:31], v[32:35], v[120:135]
    ds_read_b64_tr_b16 v[60:61], v23 offset:24576
    ds_read_b64_tr_b16 v[62:63], v23 offset:25600
    ds_read_b128 v[68:71], v20 offset:36864
    s_add_u32 m0, s79, 16384
    s_add_u32 s77, s77, 110592
    s_cmp_eq_u32 s77, 2211840
    s_cselect_b32 s77, 0, s77
    buffer_load_dwordx4 v16, s[52:55], s77 offen offset:0 lds
    v_mfma_f32_32x32x16_bf16 v[104:119], v[24:27], v[36:39], v[104:119]
    ds_read_b64_tr_b16 v[72:73], v22 offset:28672
    ds_read_b64_tr_b16 v[74:75], v22 offset:29696
    ds_read_b128 v[80:83], v21 offset:32768
    v_mfma_f32_32x32x16_bf16 v[136:151], v[28:31], v[36:39], v[136:151]
    ds_read_b64_tr_b16 v[76:77], v23 offset:28672
    ds_read_b64_tr_b16 v[78:79], v23 offset:29696
    ds_read_b128 v[84:87], v21 offset:36864
    buffer_load_dwordx4 v17, s[52:55], s77 offen offset:1024 lds
    v_mfma_f32_32x32x16_bf16 v[88:103], v[40:43], v[48:51], v[88:103]
    v_mfma_f32_32x32x16_bf16 v[120:135], v[44:47], v[48:51], v[120:135]
    s_add_u32 m0, s78, 16384
    s_nop 0
    buffer_load_dwordx4 v14, s[48:51], s76 offen offset:2048 lds
    v_mfma_f32_32x32x16_bf16 v[104:119], v[40:43], v[52:55], v[104:119]
    buffer_load_dwordx4 v15, s[48:51], s76 offen offset:3072 lds
    v_mfma_f32_32x32x16_bf16 v[136:151], v[44:47], v[52:55], v[136:151]
    s_waitcnt vmcnt(15) lgkmcnt(0)
    s_barrier
    v_mfma_f32_32x32x16_bf16 v[88:103], v[56:59], v[64:67], v[88:103]
    ds_read_b64_tr_b16 v[24:25], v22 offset:32768
    ds_read_b64_tr_b16 v[26:27], v22 offset:33792
    ds_read_b128 v[32:35], v18 offset:49152
    v_mfma_f32_32x32x16_bf16 v[120:135], v[60:63], v[64:67], v[120:135]
    ds_read_b64_tr_b16 v[28:29], v23 offset:32768
    ds_read_b64_tr_b16 v[30:31], v23 offset:33792
    ds_read_b128 v[36:39], v18 offset:53248
    s_add_u32 m0, s79, 24576
    s_add_u32 s77, s77, 110592
    s_cmp_eq_u32 s77, 2211840
    s_cselect_b32 s77, 0, s77
    buffer_load_dwordx4 v16, s[52:55], s77 offen offset:0 lds
    v_mfma_f32_32x32x16_bf16 v[104:119], v[56:59], v[68:71], v[104:119]
    ds_read_b64_tr_b16 v[40:41], v22 offset:36864
    ds_read_b64_tr_b16 v[42:43], v22 offset:37888
    ds_read_b128 v[48:51], v19 offset:49152
    s_mul_i32 s81, s5, 54
    s_add_u32 s81, s81, s6
    s_mul_i32 s81, s81, 5120
    s_add_u32 s81, s81, 20971520
    s_mul_i32 s84, s3, 25600
    s_cmp_ge_u32 s3, 2
    s_cselect_b32 s95, 13, 14
    s_mul_i32 s94, s5, 13
    s_lshr_b32 s94, s94, 3
    s_lshr_b32 s85, s4, 2
    s_mul_i32 s85, s85, 13
    s_lshr_b32 s85, s85, 3
    s_add_u32 s94, s94, s85
    s_cmp_ge_u32 s94, s95
    s_cselect_b32 s85, s95, 0
    s_sub_u32 s94, s94, s85
    v_mfma_f32_32x32x16_bf16 v[136:151], v[60:63], v[68:71], v[136:151]
    ds_read_b64_tr_b16 v[44:45], v23 offset:36864
    ds_read_b64_tr_b16 v[46:47], v23 offset:37888
    ds_read_b128 v[52:55], v19 offset:53248
    buffer_load_dwordx4 v17, s[52:55], s77 offen offset:1024 lds
    v_mfma_f32_32x32x16_bf16 v[88:103], v[72:75], v[80:83], v[88:103]
    s_waitcnt vmcnt(10)
    v_min_u32 v2, v4, v5
    v_cmp_ne_u32 s[10:11], 0, v2
    v_cmp_eq_u64 vcc, v[4:5], v[6:7]
    s_nop 0
    s_and_b64 vcc, vcc, s[10:11]
    s_cmp_eq_u64 vcc, -1
    s_cselect_b32 s14, 1, 0
    v_mfma_f32_32x32x16_bf16 v[120:135], v[76:79], v[80:83], v[120:135]
    v_mfma_f32_32x32x16_bf16 v[104:119], v[72:75], v[84:87], v[104:119]
    v_mfma_f32_32x32x16_bf16 v[136:151], v[76:79], v[84:87], v[136:151]
    s_waitcnt lgkmcnt(0)
    s_barrier
    v_mfma_f32_32x32x16_bf16 v[88:103], v[24:27], v[32:35], v[88:103]
    ds_read_b64_tr_b16 v[56:57], v22 offset:0
    ds_read_b64_tr_b16 v[58:59], v22 offset:1024
    ds_read_b128 v[64:67], v20 offset:49152
    v_mfma_f32_32x32x16_bf16 v[120:135], v[28:31], v[32:35], v[120:135]
    ds_read_b64_tr_b16 v[60:61], v23 offset:0
    ds_read_b64_tr_b16 v[62:63], v23 offset:1024
    ds_read_b128 v[68:71], v20 offset:53248
    s_add_u32 m0, s79, 32768
    s_add_u32 s77, s77, 110592
    s_cmp_eq_u32 s77, 2211840
    s_cselect_b32 s77, 0, s77
    buffer_load_dwordx4 v16, s[52:55], s77 offen offset:0 lds
    v_mfma_f32_32x32x16_bf16 v[104:119], v[24:27], v[36:39], v[104:119]
    ds_read_b64_tr_b16 v[72:73], v22 offset:4096
    ds_read_b64_tr_b16 v[74:75], v22 offset:5120
    ds_read_b128 v[80:83], v21 offset:49152
    v_mfma_f32_32x32x16_bf16 v[136:151], v[28:31], v[36:39], v[136:151]
    ds_read_b64_tr_b16 v[76:77], v23 offset:4096
    ds_read_b64_tr_b16 v[78:79], v23 offset:5120
    ds_read_b128 v[84:87], v21 offset:53248
    buffer_load_dwordx4 v17, s[52:55], s77 offen offset:1024 lds
    v_mfma_f32_32x32x16_bf16 v[88:103], v[40:43], v[48:51], v[88:103]
    s_add_u32 s85, s94, 0
    s_cmp_ge_u32 s85, s95
    s_cselect_b32 s15, s95, 0
    s_sub_u32 s85, s85, s15
    s_mul_i32 s85, s85, 5120
    s_add_u32 s83, s85, s81
    buffer_load_dwordx4 v[156:159], v9, s[60:63], s83 offen offset:0 sc1
    v_mfma_f32_32x32x16_bf16 v[120:135], v[44:47], v[48:51], v[120:135]
    v_mfma_f32_32x32x16_bf16 v[104:119], v[40:43], v[52:55], v[104:119]
    buffer_load_dwordx4 v[160:163], v9, s[60:63], s83 offen offset:1024 sc1
    v_mfma_f32_32x32x16_bf16 v[136:151], v[44:47], v[52:55], v[136:151]
    s_waitcnt vmcnt(12) lgkmcnt(0)
    s_barrier
    v_mfma_f32_32x32x16_bf16 v[88:103], v[56:59], v[64:67], v[88:103]
    ds_read_b64_tr_b16 v[24:25], v22 offset:8192
    ds_read_b64_tr_b16 v[26:27], v22 offset:9216
    ds_read_b128 v[32:35], v18 offset:0
    v_mfma_f32_32x32x16_bf16 v[120:135], v[60:63], v[64:67], v[120:135]
    ds_read_b64_tr_b16 v[28:29], v23 offset:8192
    ds_read_b64_tr_b16 v[30:31], v23 offset:9216
    ds_read_b128 v[36:39], v18 offset:4096
    v_mfma_f32_32x32x16_bf16 v[104:119], v[56:59], v[68:71], v[104:119]
    ds_read_b64_tr_b16 v[40:41], v22 offset:12288
    ds_read_b64_tr_b16 v[42:43], v22 offset:13312
    ds_read_b128 v[48:51], v19 offset:0
    buffer_load_dwordx4 v[164:167], v9, s[60:63], s83 offen offset:2048 sc1
    v_mfma_f32_32x32x16_bf16 v[136:151], v[60:63], v[68:71], v[136:151]
    ds_read_b64_tr_b16 v[44:45], v23 offset:12288
    ds_read_b64_tr_b16 v[46:47], v23 offset:13312
    ds_read_b128 v[52:55], v19 offset:4096
    v_mfma_f32_32x32x16_bf16 v[88:103], v[72:75], v[80:83], v[88:103]
    buffer_load_dwordx4 v[168:171], v9, s[60:63], s83 offen offset:3072 sc1
    v_mfma_f32_32x32x16_bf16 v[120:135], v[76:79], v[80:83], v[120:135]
    v_mfma_f32_32x32x16_bf16 v[104:119], v[72:75], v[84:87], v[104:119]
    s_add_u32 s83, s83, 4096
    buffer_load_dwordx4 v[172:175], v9, s[60:63], s83 offen offset:0 sc1
    v_mfma_f32_32x32x16_bf16 v[136:151], v[76:79], v[84:87], v[136:151]
    s_waitcnt vmcnt(11) lgkmcnt(0)
    s_barrier
    v_mfma_f32_32x32x16_bf16 v[88:103], v[24:27], v[32:35], v[88:103]
    ds_read_b64_tr_b16 v[56:57], v22 offset:16384
    ds_read_b64_tr_b16 v[58:59], v22 offset:17408
    ds_read_b128 v[64:67], v20 offset:0
    v_mfma_f32_32x32x16_bf16 v[120:135], v[28:31], v[32:35], v[120:135]
    ds_read_b64_tr_b16 v[60:61], v23 offset:16384
    ds_read_b64_tr_b16 v[62:63], v23 offset:17408
    ds_read_b128 v[68:71], v20 offset:4096
    v_mfma_f32_32x32x16_bf16 v[104:119], v[24:27], v[36:39], v[104:119]
    ds_read_b64_tr_b16 v[72:73], v22 offset:20480
    ds_read_b64_tr_b16 v[74:75], v22 offset:21504
    ds_read_b128 v[80:83], v21 offset:0
    s_add_u32 s85, s94, 1
    s_cmp_ge_u32 s85, s95
    s_cselect_b32 s15, s95, 0
    s_sub_u32 s85, s85, s15
    s_mul_i32 s85, s85, 5120
    s_add_u32 s83, s85, s81
    buffer_load_dwordx4 v[176:179], v9, s[60:63], s83 offen offset:0 sc1
    v_mfma_f32_32x32x16_bf16 v[136:151], v[28:31], v[36:39], v[136:151]
    ds_read_b64_tr_b16 v[76:77], v23 offset:20480
    ds_read_b64_tr_b16 v[78:79], v23 offset:21504
    ds_read_b128 v[84:87], v21 offset:4096
    v_mfma_f32_32x32x16_bf16 v[88:103], v[40:43], v[48:51], v[88:103]
    buffer_load_dwordx4 v[180:183], v9, s[60:63], s83 offen offset:1024 sc1
    v_mfma_f32_32x32x16_bf16 v[120:135], v[44:47], v[48:51], v[120:135]
    v_mfma_f32_32x32x16_bf16 v[104:119], v[40:43], v[52:55], v[104:119]
    buffer_load_dwordx4 v[184:187], v9, s[60:63], s83 offen offset:2048 sc1
    v_mfma_f32_32x32x16_bf16 v[136:151], v[44:47], v[52:55], v[136:151]
    s_waitcnt vmcnt(10) lgkmcnt(0)
    s_barrier
    v_mfma_f32_32x32x16_bf16 v[88:103], v[56:59], v[64:67], v[88:103]
    ds_read_b64_tr_b16 v[24:25], v22 offset:24576
    ds_read_b64_tr_b16 v[26:27], v22 offset:25600
    ds_read_b128 v[32:35], v18 offset:16384
    v_mfma_f32_32x32x16_bf16 v[120:135], v[60:63], v[64:67], v[120:135]
    ds_read_b64_tr_b16 v[28:29], v23 offset:24576
    ds_read_b64_tr_b16 v[30:31], v23 offset:25600
    ds_read_b128 v[36:39], v18 offset:20480
    v_mfma_f32_32x32x16_bf16 v[104:119], v[56:59], v[68:71], v[104:119]
    ds_read_b64_tr_b16 v[40:41], v22 offset:28672
    ds_read_b64_tr_b16 v[42:43], v22 offset:29696
    ds_read_b128 v[48:51], v19 offset:16384
    buffer_load_dwordx4 v[188:191], v9, s[60:63], s83 offen offset:3072 sc1
    v_mfma_f32_32x32x16_bf16 v[136:151], v[60:63], v[68:71], v[136:151]
    ds_read_b64_tr_b16 v[44:45], v23 offset:28672
    ds_read_b64_tr_b16 v[46:47], v23 offset:29696
    ds_read_b128 v[52:55], v19 offset:20480
    v_mfma_f32_32x32x16_bf16 v[88:103], v[72:75], v[80:83], v[88:103]
    s_add_u32 s83, s83, 4096
    buffer_load_dwordx4 v[192:195], v9, s[60:63], s83 offen offset:0 sc1
    v_mfma_f32_32x32x16_bf16 v[120:135], v[76:79], v[80:83], v[120:135]
    v_mfma_f32_32x32x16_bf16 v[104:119], v[72:75], v[84:87], v[104:119]
    s_add_u32 s85, s94, 2
    s_cmp_ge_u32 s85, s95
    s_cselect_b32 s15, s95, 0
    s_sub_u32 s85, s85, s15
    s_mul_i32 s85, s85, 5120
    s_add_u32 s83, s85, s81
    buffer_load_dwordx4 v[196:199], v9, s[60:63], s83 offen offset:0 sc1
    v_mfma_f32_32x32x16_bf16 v[136:151], v[76:79], v[84:87], v[136:151]
    s_waitcnt vmcnt(11) lgkmcnt(0)
    s_barrier
    v_mfma_f32_32x32x16_bf16 v[88:103], v[24:27], v[32:35], v[88:103]
    ds_read_b64_tr_b16 v[56:57], v22 offset:32768
    ds_read_b64_tr_b16 v[58:59], v22 offset:33792
    ds_read_b128 v[64:67], v20 offset:16384
    v_mfma_f32_32x32x16_bf16 v[120:135], v[28:31], v[32:35], v[120:135]
    ds_read_b64_tr_b16 v[60:61], v23 offset:32768
    ds_read_b64_tr_b16 v[62:63], v23 offset:33792
    ds_read_b128 v[68:71], v20 offset:20480
    v_mfma_f32_32x32x16_bf16 v[104:119], v[24:27], v[36:39], v[104:119]
    ds_read_b64_tr_b16 v[72:73], v22 offset:36864
    ds_read_b64_tr_b16 v[74:75], v22 offset:37888
    ds_read_b128 v[80:83], v21 offset:16384
    buffer_load_dwordx4 v[200:203], v9, s[60:63], s83 offen offset:1024 sc1
    v_mfma_f32_32x32x16_bf16 v[136:151], v[28:31], v[36:39], v[136:151]
    ds_read_b64_tr_b16 v[76:77], v23 offset:36864
    ds_read_b64_tr_b16 v[78:79], v23 offset:37888
    ds_read_b128 v[84:87], v21 offset:20480
    v_mfma_f32_32x32x16_bf16 v[88:103], v[40:43], v[48:51], v[88:103]
    buffer_load_dwordx4 v[204:207], v9, s[60:63], s83 offen offset:2048 sc1
    v_mfma_f32_32x32x16_bf16 v[120:135], v[44:47], v[48:51], v[120:135]
    v_mfma_f32_32x32x16_bf16 v[104:119], v[40:43], v[52:55], v[104:119]
    buffer_load_dwordx4 v[208:211], v9, s[60:63], s83 offen offset:3072 sc1
    v_mfma_f32_32x32x16_bf16 v[136:151], v[44:47], v[52:55], v[136:151]
    s_waitcnt lgkmcnt(0)
    s_barrier
    v_mfma_f32_32x32x16_bf16 v[88:103], v[56:59], v[64:67], v[88:103]
    v_mfma_f32_32x32x16_bf16 v[88:103], v[72:75], v[80:83], v[88:103]
    v_mfma_f32_32x32x16_bf16 v[120:135], v[60:63], v[64:67], v[120:135]
    s_add_u32 s83, s83, 4096
    buffer_load_dwordx4 v[212:215], v9, s[60:63], s83 offen offset:0 sc1
    v_mfma_f32_32x32x16_bf16 v[120:135], v[76:79], v[80:83], v[120:135]
    v_mfma_f32_32x32x16_bf16 v[104:119], v[56:59], v[68:71], v[104:119]
    s_add_u32 s85, s94, 3
    s_cmp_ge_u32 s85, s95
    s_cselect_b32 s15, s95, 0
    s_sub_u32 s85, s85, s15
    s_mul_i32 s85, s85, 5120
    s_add_u32 s83, s85, s81
    buffer_load_dwordx4 v[216:219], v9, s[60:63], s83 offen offset:0 sc1
    v_mfma_f32_32x32x16_bf16 v[104:119], v[72:75], v[84:87], v[104:119]
    v_mfma_f32_32x32x16_bf16 v[136:151], v[60:63], v[68:71], v[136:151]
    buffer_load_dwordx4 v[220:223], v9, s[60:63], s83 offen offset:1024 sc1
    v_mfma_f32_32x32x16_bf16 v[136:151], v[76:79], v[84:87], v[136:151]
    s_setprio 3
    s_nop 4
    v_cvt_pk_bf16_f32 v24, v88, v89
    v_cvt_pk_bf16_f32 v25, v90, v91
    v_cvt_pk_bf16_f32 v26, v92, v93
    v_cvt_pk_bf16_f32 v27, v94, v95
    v_pk_max_i16 v24, v24, 0
    v_pk_max_i16 v25, v25, 0
    v_pk_max_i16 v26, v26, 0
    v_pk_max_i16 v27, v27, 0
    buffer_store_dwordx4 v[24:27], v152, s[60:63], s12 offen offset:0 sc1
    v_cvt_pk_bf16_f32 v28, v96, v97
    v_cvt_pk_bf16_f32 v29, v98, v99
    v_cvt_pk_bf16_f32 v30, v100, v101
    v_cvt_pk_bf16_f32 v31, v102, v103
    v_pk_max_i16 v28, v28, 0
    v_pk_max_i16 v29, v29, 0
    v_pk_max_i16 v30, v30, 0
    v_pk_max_i16 v31, v31, 0
    buffer_store_dwordx4 v[28:31], v152, s[60:63], s12 offen offset:512 sc1
    v_cvt_pk_bf16_f32 v32, v120, v121
    v_cvt_pk_bf16_f32 v33, v122, v123
    v_cvt_pk_bf16_f32 v34, v124, v125
    v_cvt_pk_bf16_f32 v35, v126, v127
    v_pk_max_i16 v32, v32, 0
    v_pk_max_i16 v33, v33, 0
    v_pk_max_i16 v34, v34, 0
    v_pk_max_i16 v35, v35, 0
    buffer_store_dwordx4 v[32:35], v154, s[60:63], s13 offen offset:0 sc1
    v_cvt_pk_bf16_f32 v36, v128, v129
    v_cvt_pk_bf16_f32 v37, v130, v131
    v_cvt_pk_bf16_f32 v38, v132, v133
    v_cvt_pk_bf16_f32 v39, v134, v135
    v_pk_max_i16 v36, v36, 0
    v_pk_max_i16 v37, v37, 0
    v_pk_max_i16 v38, v38, 0
    v_pk_max_i16 v39, v39, 0
    buffer_store_dwordx4 v[36:39], v154, s[60:63], s13 offen offset:512 sc1
    v_cvt_pk_bf16_f32 v40, v104, v105
    v_cvt_pk_bf16_f32 v41, v106, v107
    v_cvt_pk_bf16_f32 v42, v108, v109
    v_cvt_pk_bf16_f32 v43, v110, v111
    v_pk_max_i16 v40, v40, 0
    v_pk_max_i16 v41, v41, 0
    v_pk_max_i16 v42, v42, 0
    v_pk_max_i16 v43, v43, 0
    buffer_store_dwordx4 v[40:43], v153, s[60:63], s12 offen offset:0 sc1
    v_cvt_pk_bf16_f32 v44, v112, v113
    v_cvt_pk_bf16_f32 v45, v114, v115
    v_cvt_pk_bf16_f32 v46, v116, v117
    v_cvt_pk_bf16_f32 v47, v118, v119
    v_pk_max_i16 v44, v44, 0
    v_pk_max_i16 v45, v45, 0
    v_pk_max_i16 v46, v46, 0
    v_pk_max_i16 v47, v47, 0
    buffer_store_dwordx4 v[44:47], v153, s[60:63], s12 offen offset:512 sc1
    v_cvt_pk_bf16_f32 v48, v136, v137
    v_cvt_pk_bf16_f32 v49, v138, v139
    v_cvt_pk_bf16_f32 v50, v140, v141
    v_cvt_pk_bf16_f32 v51, v142, v143
    v_pk_max_i16 v48, v48, 0
    v_pk_max_i16 v49, v49, 0
    v_pk_max_i16 v50, v50, 0
    v_pk_max_i16 v51, v51, 0
    buffer_store_dwordx4 v[48:51], v155, s[60:63], s13 offen offset:0 sc1
    v_cvt_pk_bf16_f32 v52, v144, v145
    v_cvt_pk_bf16_f32 v53, v146, v147
    v_cvt_pk_bf16_f32 v54, v148, v149
    v_cvt_pk_bf16_f32 v55, v150, v151
    v_pk_max_i16 v52, v52, 0
    v_pk_max_i16 v53, v53, 0
    v_pk_max_i16 v54, v54, 0
    v_pk_max_i16 v55, v55, 0
    buffer_store_dwordx4 v[52:55], v155, s[60:63], s13 offen offset:512 sc1
L_g2:
    s_mov_b32 s64, s42
    s_mov_b32 s65, s43
    s_mov_b32 s66, 0x280000
    s_mov_b32 s67, 0x00020000
    s_cmp_eq_u32 s14, 1
    s_cbranch_scc1 L_frok_1
    s_waitcnt vmcnt(0)
    v_min_u32 v2, v4, v5
    v_cmp_eq_u32 vcc, 0, v2
    s_cbranch_vccnz L_nl_2
L_nd_3:
    s_mov_b64 exec, 1
    buffer_store_dwordx2 v[4:5], v8, s[60:63], s9 offen sc1
    s_mov_b64 exec, -1
    v_cmp_eq_u64 vcc, v[4:5], v[6:7]
    s_nop 0
    s_cmp_eq_u64 vcc, -1
    s_cbranch_scc0 L_fl_5
L_fd_6:
    s_setprio 0
    s_add_u32 s85, s94, 0
    s_cmp_ge_u32 s85, s95
    s_cselect_b32 s15, s95, 0
    s_sub_u32 s85, s85, s15
    s_mul_i32 s85, s85, 5120
    s_add_u32 s83, s85, s81
    buffer_load_dwordx4 v[156:159], v9, s[60:63], s83 offen offset:0 sc1
    buffer_load_dwordx4 v[160:163], v9, s[60:63], s83 offen offset:1024 sc1
    buffer_load_dwordx4 v[164:167], v9, s[60:63], s83 offen offset:2048 sc1
    buffer_load_dwordx4 v[168:171], v9, s[60:63], s83 offen offset:3072 sc1
    s_add_u32 s83, s83, 4096
    buffer_load_dwordx4 v[172:175], v9, s[60:63], s83 offen offset:0 sc1
    s_add_u32 s85, s94, 1
    s_cmp_ge_u32 s85, s95
    s_cselect_b32 s15, s95, 0
    s_sub_u32 s85, s85, s15
    s_mul_i32 s85, s85, 5120
    s_add_u32 s83, s85, s81
    buffer_load_dwordx4 v[176:179], v9, s[60:63], s83 offen offset:0 sc1
    buffer_load_dwordx4 v[180:183], v9, s[60:63], s83 offen offset:1024 sc1
    buffer_load_dwordx4 v[184:187], v9, s[60:63], s83 offen offset:2048 sc1
    buffer_load_dwordx4 v[188:191], v9, s[60:63], s83 offen offset:3072 sc1
    s_add_u32 s83, s83, 4096
    buffer_load_dwordx4 v[192:195], v9, s[60:63], s83 offen offset:0 sc1
    s_add_u32 s85, s94, 2
    s_cmp_ge_u32 s85, s95
    s_cselect_b32 s15, s95, 0
    s_sub_u32 s85, s85, s15
    s_mul_i32 s85, s85, 5120
    s_add_u32 s83, s85, s81
    buffer_load_dwordx4 v[196:199], v9, s[60:63], s83 offen offset:0 sc1
    buffer_load_dwordx4 v[200:203], v9, s[60:63], s83 offen offset:1024 sc1
    buffer_load_dwordx4 v[204:207], v9, s[60:63], s83 offen offset:2048 sc1
    buffer_load_dwordx4 v[208:211], v9, s[60:63], s83 offen offset:3072 sc1
    s_add_u32 s83, s83, 4096
    buffer_load_dwordx4 v[212:215], v9, s[60:63], s83 offen offset:0 sc1
    s_add_u32 s85, s94, 3
    s_cmp_ge_u32 s85, s95
    s_cselect_b32 s15, s95, 0
    s_sub_u32 s85, s85, s15
    s_mul_i32 s85, s85, 5120
    s_add_u32 s83, s85, s81
    buffer_load_dwordx4 v[216:219], v9, s[60:63], s83 offen offset:0 sc1
    buffer_load_dwordx4 v[220:223], v9, s[60:63], s83 offen offset:1024 sc1
L_frok_1:
    s_setprio 0
    s_cmp_ge_u32 s3, 2
    s_cselect_b32 s10, 0x7f000000, 0
    v_add_u32 v0, s10, v9
    v_add_u32 v3, s84, v9
    buffer_load_dwordx4 v[224:227], v9, s[60:63], s83 offen offset:2048 sc1
    buffer_load_dwordx4 v[228:231], v9, s[60:63], s83 offen offset:3072 sc1
    s_add_u32 s83, s83, 4096
    buffer_load_dwordx4 v[232:235], v9, s[60:63], s83 offen offset:0 sc1
    s_add_u32 s85, s94, 4
    s_cmp_ge_u32 s85, s95
    s_cselect_b32 s15, s95, 0
    s_sub_u32 s85, s85, s15
    s_mul_i32 s85, s85, 5120
    s_add_u32 s83, s85, s81
    buffer_load_dwordx4 v[236:239], v9, s[60:63], s83 offen offset:0 sc1
    buffer_load_dwordx4 v[240:243], v9, s[60:63], s83 offen offset:1024 sc1
    buffer_load_dwordx4 v[244:247], v9, s[60:63], s83 offen offset:2048 sc1
    buffer_load_dwordx4 v[248:251], v9, s[60:63], s83 offen offset:3072 sc1
    s_add_u32 s83, s83, 4096
    buffer_load_dwordx4 v[252:255], v9, s[60:63], s83 offen offset:0 sc1
    s_add_u32 s10, s95, s6
    s_sub_u32 s10, s10, 1
    s_lshr_b32 s10, s10, 1
    s_lshr_b32 s11, s6, 1
    v_add_u32 v2, s11, v1
    v_min_u32 v2, s10, v2
    s_lshl_b32 s10, s4, 11
    s_add_u32 s10, s10, 16580608
    v_lshl_add_u32 v10, v2, 6, s10
    s_and_b32 s82, s4, 31
    s_mul_i32 s82, s82, 54
    s_add_u32 s82, s82, s6
    s_lshl_b32 s82, s82, 12
    s_lshl_b32 s77, s95, 12
    s_add_u32 s77, s77, s82
    s_lshl_b32 s76, s94, 12
    s_add_u32 s76, s76, s82
    s_mul_i32 s12, s5, 80
    s_lshl_b32 s10, s3, 2
    s_add_u32 s12, s12, s10
    s_lshl_b32 s78, s12, 6
    s_add_u32 s78, s78, 16449536
    s_lshl_b32 s13, s4, 2
    s_add_u32 s13, s13, s3
    s_lshl_b32 s79, s13, 6
    s_add_u32 s80, s79, 15728640
    s_add_u32 s79, s79, 16515072
    s_lshl_b32 s12, s12, 12
    s_lshl_b32 s10, s4, 7
    s_add_u32 s12, s12, s10
    s_add_u32 s12, s12, 12582912
    s_setprio 3
    s_waitcnt vmcnt(8)
    s_mov_b64 exec, 1
    buffer_store_dwordx2 v[4:5], v8, s[60:63], s9 offen sc1
    s_mov_b64 exec, -1
    s_setprio 0
    s_add_u32 m0, s84, 0
    s_add_u32 s85, s94, 5
    s_cmp_ge_u32 s85, s95
    s_cselect_b32 s15, s95, 0
    s_sub_u32 s85, s85, s15
    s_mul_i32 s85, s85, 5120
    s_add_u32 s83, s85, s81
    buffer_load_dwordx4 v9, s[60:63], s83 offen offset:0 sc1 lds
    buffer_load_dwordx4 v9, s[60:63], s83 offen offset:1024 sc1 lds
    buffer_load_dwordx4 v9, s[60:63], s83 offen offset:2048 sc1 lds
    buffer_load_dwordx4 v9, s[60:63], s83 offen offset:3072 sc1 lds
    s_add_u32 m0, s84, 4096
    s_add_u32 s83, s83, 4096
    buffer_load_dwordx4 v9, s[60:63], s83 offen offset:0 sc1 lds
    s_add_u32 m0, s84, 5120
    s_add_u32 s85, s94, 6
    s_cmp_ge_u32 s85, s95
    s_cselect_b32 s15, s95, 0
    s_sub_u32 s85, s85, s15
    s_mul_i32 s85, s85, 5120
    s_add_u32 s83, s85, s81
    buffer_load_dwordx4 v9, s[60:63], s83 offen offset:0 sc1 lds
    buffer_load_dwordx4 v9, s[60:63], s83 offen offset:1024 sc1 lds
    buffer_load_dwordx4 v9, s[60:63], s83 offen offset:2048 sc1 lds
    buffer_load_dwordx4 v9, s[60:63], s83 offen offset:3072 sc1 lds
    s_add_u32 m0, s84, 9216
    s_add_u32 s83, s83, 4096
    buffer_load_dwordx4 v9, s[60:63], s83 offen offset:0 sc1 lds
    s_add_u32 m0, s84, 10240
    s_add_u32 s85, s94, 8
    s_cmp_ge_u32 s85, s95
    s_cselect_b32 s15, s95, 0
    s_sub_u32 s85, s85, s15
    s_mul_i32 s85, s85, 5120
    s_add_u32 s83, s85, s81
    buffer_load_dwordx4 v9, s[60:63], s83 offen offset:0 sc1 lds
    buffer_load_dwordx4 v9, s[60:63], s83 offen offset:1024 sc1 lds
    buffer_load_dwordx4 v9, s[60:63], s83 offen offset:2048 sc1 lds
    buffer_load_dwordx4 v9, s[60:63], s83 offen offset:3072 sc1 lds
    s_add_u32 m0, s84, 14336
    s_add_u32 s83, s83, 4096
    buffer_load_dwordx4 v9, s[60:63], s83 offen offset:0 sc1 lds
    s_add_u32 m0, s84, 15360
    s_add_u32 s85, s94, 10
    s_cmp_ge_u32 s85, s95
    s_cselect_b32 s15, s95, 0
    s_sub_u32 s85, s85, s15
    s_mul_i32 s85, s85, 5120
    s_add_u32 s83, s85, s81
    buffer_load_dwordx4 v9, s[60:63], s83 offen offset:0 sc1 lds
    buffer_load_dwordx2 v[6:7], v10, s[60:63], 0 offen sc1
    buffer_load_dwordx4 v9, s[60:63], s83 offen offset:1024 sc1 lds
    buffer_load_dwordx4 v9, s[60:63], s83 offen offset:2048 sc1 lds
    buffer_load_dwordx4 v9, s[60:63], s83 offen offset:3072 sc1 lds
    s_add_u32 m0, s84, 19456
    s_add_u32 s83, s83, 4096
    buffer_load_dwordx4 v9, s[60:63], s83 offen offset:0 sc1 lds
    s_add_u32 m0, s84, 20480
    s_add_u32 s85, s94, 12
    s_cmp_ge_u32 s85, s95
    s_cselect_b32 s15, s95, 0
    s_sub_u32 s85, s85, s15
    s_mul_i32 s85, s85, 5120
    s_add_u32 s83, s85, s81
    buffer_load_dwordx4 v9, s[60:63], s83 offen offset:0 sc1 lds
    buffer_load_dwordx4 v9, s[60:63], s83 offen offset:1024 sc1 lds
    buffer_load_dwordx4 v9, s[60:63], s83 offen offset:2048 sc1 lds
    buffer_load_dwordx4 v9, s[60:63], s83 offen offset:3072 sc1 lds
    s_add_u32 m0, s84, 24576
    s_add_u32 s83, s83, 4096
    buffer_load_dwordx4 v9, s[60:63], s83 offen offset:0 sc1 lds
    s_waitcnt vmcnt(9)
    v_cmp_eq_u64 vcc, v[4:5], v[6:7]
    s_nop 0
    s_cmp_eq_u64 vcc, -1
    s_cbranch_scc0 L_fl_8
L_fd_9:
    buffer_load_dwordx4 v[92:95], v9, s[60:63], s76 offen offset:0 sc1
    buffer_load_dwordx4 v[96:99], v9, s[60:63], s76 offen offset:1024 sc1
    buffer_load_dwordx4 v[100:103], v9, s[60:63], s76 offen offset:2048 sc1
    buffer_load_dwordx4 v[104:107], v9, s[60:63], s76 offen offset:3072 sc1
    s_add_u32 s76, s76, 4096
    s_cmp_eq_u32 s76, s77
    s_cselect_b32 s76, s82, s76
    buffer_load_dwordx4 v[108:111], v9, s[60:63], s76 offen offset:0 sc1
    buffer_load_dwordx4 v[112:115], v9, s[60:63], s76 offen offset:1024 sc1
    buffer_load_dwordx4 v[116:119], v9, s[60:63], s76 offen offset:2048 sc1
    buffer_load_dwordx4 v[120:123], v9, s[60:63], s76 offen offset:3072 sc1
    s_add_u32 s76, s76, 4096
    s_cmp_eq_u32 s76, s77
    s_cselect_b32 s76, s82, s76
    buffer_load_dwordx4 v[124:127], v9, s[60:63], s76 offen offset:0 sc1
    buffer_load_dwordx4 v[128:131], v9, s[60:63], s76 offen offset:1024 sc1
    buffer_load_dwordx4 v[132:135], v9, s[60:63], s76 offen offset:2048 sc1
    buffer_load_dwordx4 v[136:139], v9, s[60:63], s76 offen offset:3072 sc1
    s_add_u32 s76, s76, 4096
    s_cmp_eq_u32 s76, s77
    s_cselect_b32 s76, s82, s76
    buffer_load_dwordx4 v[140:143], v9, s[60:63], s76 offen offset:0 sc1
    buffer_load_dwordx4 v[144:147], v9, s[60:63], s76 offen offset:1024 sc1
    buffer_load_dwordx4 v[148:151], v9, s[60:63], s76 offen offset:2048 sc1
    buffer_load_dwordx4 v[152:155], v9, s[60:63], s76 offen offset:3072 sc1
    s_add_u32 s76, s76, 4096
    s_cmp_eq_u32 s76, s77
    s_cselect_b32 s76, s82, s76
    v_lshrrev_b32 v2, 2, v1
    v_lshlrev_b32 v2, 4, v2
    v_and_b32 v10, 3, v1
    v_add_u32 v2, v2, v10
    v_lshl_add_u32 v10, v2, 6, s78
    v_cmp_gt_u32 vcc, 20, v1
    v_mov_b32 v2, s79
    s_nop 0
    v_cndmask_b32 v10, v2, v10, vcc
    s_waitcnt vmcnt(12)
    v_mfma_f32_16x16x32_bf16 v[12:15], v[156:159], v[92:95], 0
    v_mfma_f32_16x16x32_bf16 v[16:19], v[156:159], v[96:99], 0
    v_mfma_f32_16x16x32_bf16 v[20:23], v[156:159], v[100:103], 0
    v_mfma_f32_16x16x32_bf16 v[24:27], v[156:159], v[104:107], 0
    v_mfma_f32_16x16x32_bf16 v[28:31], v[160:163], v[92:95], 0
    v_mfma_f32_16x16x32_bf16 v[32:35], v[160:163], v[96:99], 0
    v_mfma_f32_16x16x32_bf16 v[36:39], v[160:163], v[100:103], 0
    v_mfma_f32_16x16x32_bf16 v[40:43], v[160:163], v[104:107], 0
    v_mfma_f32_16x16x32_bf16 v[44:47], v[164:167], v[92:95], 0
    v_mfma_f32_16x16x32_bf16 v[48:51], v[164:167], v[96:99], 0
    v_mfma_f32_16x16x32_bf16 v[52:55], v[164:167], v[100:103], 0
    v_mfma_f32_16x16x32_bf16 v[56:59], v[164:167], v[104:107], 0
    v_mfma_f32_16x16x32_bf16 v[60:63], v[168:171], v[92:95], 0
    v_mfma_f32_16x16x32_bf16 v[64:67], v[168:171], v[96:99], 0
    v_mfma_f32_16x16x32_bf16 v[68:71], v[168:171], v[100:103], 0
    v_mfma_f32_16x16x32_bf16 v[72:75], v[168:171], v[104:107], 0
    v_mfma_f32_16x16x32_bf16 v[76:79], v[172:175], v[92:95], 0
    v_mfma_f32_16x16x32_bf16 v[80:83], v[172:175], v[96:99], 0
    v_mfma_f32_16x16x32_bf16 v[84:87], v[172:175], v[100:103], 0
    v_mfma_f32_16x16x32_bf16 v[88:91], v[172:175], v[104:107], 0
    s_waitcnt vmcnt(8)
    v_mfma_f32_16x16x32_bf16 v[12:15], v[176:179], v[108:111], v[12:15]
    v_mfma_f32_16x16x32_bf16 v[16:19], v[176:179], v[112:115], v[16:19]
    buffer_load_dwordx4 v[92:95], v9, s[60:63], s76 offen offset:0 sc1
    v_mfma_f32_16x16x32_bf16 v[20:23], v[176:179], v[116:119], v[20:23]
    v_mfma_f32_16x16x32_bf16 v[24:27], v[176:179], v[120:123], v[24:27]
    v_mfma_f32_16x16x32_bf16 v[28:31], v[180:183], v[108:111], v[28:31]
    v_mfma_f32_16x16x32_bf16 v[32:35], v[180:183], v[112:115], v[32:35]
    buffer_load_dwordx4 v[96:99], v9, s[60:63], s76 offen offset:1024 sc1
    v_mfma_f32_16x16x32_bf16 v[36:39], v[180:183], v[116:119], v[36:39]
    v_mfma_f32_16x16x32_bf16 v[40:43], v[180:183], v[120:123], v[40:43]
    v_mfma_f32_16x16x32_bf16 v[44:47], v[184:187], v[108:111], v[44:47]
    v_mfma_f32_16x16x32_bf16 v[48:51], v[184:187], v[112:115], v[48:51]
    buffer_load_dwordx4 v[100:103], v9, s[60:63], s76 offen offset:2048 sc1
    v_mfma_f32_16x16x32_bf16 v[52:55], v[184:187], v[116:119], v[52:55]
    v_mfma_f32_16x16x32_bf16 v[56:59], v[184:187], v[120:123], v[56:59]
    v_mfma_f32_16x16x32_bf16 v[60:63], v[188:191], v[108:111], v[60:63]
    v_mfma_f32_16x16x32_bf16 v[64:67], v[188:191], v[112:115], v[64:67]
    buffer_load_dwordx4 v[104:107], v9, s[60:63], s76 offen offset:3072 sc1
    v_mfma_f32_16x16x32_bf16 v[68:71], v[188:191], v[116:119], v[68:71]
    v_mfma_f32_16x16x32_bf16 v[72:75], v[188:191], v[120:123], v[72:75]
    v_mfma_f32_16x16x32_bf16 v[76:79], v[192:195], v[108:111], v[76:79]
    s_add_u32 s76, s76, 4096
    v_mfma_f32_16x16x32_bf16 v[80:83], v[192:195], v[112:115], v[80:83]
    v_mfma_f32_16x16x32_bf16 v[84:87], v[192:195], v[116:119], v[84:87]
    s_cmp_eq_u32 s76, s77
    s_cselect_b32 s76, s82, s76
    v_mfma_f32_16x16x32_bf16 v[88:91], v[192:195], v[120:123], v[88:91]
    s_waitcnt vmcnt(8)
    v_mfma_f32_16x16x32_bf16 v[12:15], v[196:199], v[124:127], v[12:15]
    ds_read_b128 v[156:159], v3 offset:0
    v_mfma_f32_16x16x32_bf16 v[16:19], v[196:199], v[128:131], v[16:19]
    buffer_load_dwordx4 v[108:111], v9, s[60:63], s76 offen offset:0 sc1
    v_mfma_f32_16x16x32_bf16 v[20:23], v[196:199], v[132:135], v[20:23]
    v_mfma_f32_16x16x32_bf16 v[24:27], v[196:199], v[136:139], v[24:27]
    v_mfma_f32_16x16x32_bf16 v[28:31], v[200:203], v[124:127], v[28:31]
    ds_read_b128 v[160:163], v3 offset:1024
    v_mfma_f32_16x16x32_bf16 v[32:35], v[200:203], v[128:131], v[32:35]
    buffer_load_dwordx4 v[112:115], v9, s[60:63], s76 offen offset:1024 sc1
    v_mfma_f32_16x16x32_bf16 v[36:39], v[200:203], v[132:135], v[36:39]
    v_mfma_f32_16x16x32_bf16 v[40:43], v[200:203], v[136:139], v[40:43]
    v_mfma_f32_16x16x32_bf16 v[44:47], v[204:207], v[124:127], v[44:47]
    ds_read_b128 v[164:167], v3 offset:2048
    v_mfma_f32_16x16x32_bf16 v[48:51], v[204:207], v[128:131], v[48:51]
    buffer_load_dwordx4 v[116:119], v9, s[60:63], s76 offen offset:2048 sc1
    v_mfma_f32_16x16x32_bf16 v[52:55], v[204:207], v[132:135], v[52:55]
    v_mfma_f32_16x16x32_bf16 v[56:59], v[204:207], v[136:139], v[56:59]
    v_mfma_f32_16x16x32_bf16 v[60:63], v[208:211], v[124:127], v[60:63]
    ds_read_b128 v[168:171], v3 offset:3072
    v_mfma_f32_16x16x32_bf16 v[64:67], v[208:211], v[128:131], v[64:67]
    buffer_load_dwordx4 v[120:123], v9, s[60:63], s76 offen offset:3072 sc1
    v_mfma_f32_16x16x32_bf16 v[68:71], v[208:211], v[132:135], v[68:71]
    v_mfma_f32_16x16x32_bf16 v[72:75], v[208:211], v[136:139], v[72:75]
    v_mfma_f32_16x16x32_bf16 v[76:79], v[212:215], v[124:127], v[76:79]
    ds_read_b128 v[172:175], v3 offset:4096
    s_add_u32 s76, s76, 4096
    v_mfma_f32_16x16x32_bf16 v[80:83], v[212:215], v[128:131], v[80:83]
    v_mfma_f32_16x16x32_bf16 v[84:87], v[212:215], v[132:135], v[84:87]
    s_cmp_eq_u32 s76, s77
    s_cselect_b32 s76, s82, s76
    v_mfma_f32_16x16x32_bf16 v[88:91], v[212:215], v[136:139], v[88:91]
    s_waitcnt vmcnt(8)
    v_mfma_f32_16x16x32_bf16 v[12:15], v[216:219], v[140:143], v[12:15]
    ds_read_b128 v[176:179], v3 offset:5120
    s_add_u32 s85, s94, 7
    v_mfma_f32_16x16x32_bf16 v[16:19], v[216:219], v[144:147], v[16:19]
    buffer_load_dwordx4 v[124:127], v9, s[60:63], s76 offen offset:0 sc1
    s_cmp_ge_u32 s85, s95
    s_cselect_b32 s15, s95, 0
    v_mfma_f32_16x16x32_bf16 v[20:23], v[216:219], v[148:151], v[20:23]
    s_sub_u32 s85, s85, s15
    s_mul_i32 s85, s85, 5120
    s_add_u32 s83, s85, s81
    v_mfma_f32_16x16x32_bf16 v[24:27], v[216:219], v[152:155], v[24:27]
    buffer_load_dwordx4 v[196:199], v9, s[60:63], s83 offen offset:0 sc1
    v_mfma_f32_16x16x32_bf16 v[28:31], v[220:223], v[140:143], v[28:31]
    ds_read_b128 v[180:183], v3 offset:6144
    v_mfma_f32_16x16x32_bf16 v[32:35], v[220:223], v[144:147], v[32:35]
    buffer_load_dwordx4 v[128:131], v9, s[60:63], s76 offen offset:1024 sc1
    v_mfma_f32_16x16x32_bf16 v[36:39], v[220:223], v[148:151], v[36:39]
    v_mfma_f32_16x16x32_bf16 v[40:43], v[220:223], v[152:155], v[40:43]
    buffer_load_dwordx4 v[200:203], v9, s[60:63], s83 offen offset:1024 sc1
    v_mfma_f32_16x16x32_bf16 v[44:47], v[224:227], v[140:143], v[44:47]
    ds_read_b128 v[184:187], v3 offset:7168
    v_mfma_f32_16x16x32_bf16 v[48:51], v[224:227], v[144:147], v[48:51]
    buffer_load_dwordx4 v[132:135], v9, s[60:63], s76 offen offset:2048 sc1
    v_mfma_f32_16x16x32_bf16 v[52:55], v[224:227], v[148:151], v[52:55]
    v_mfma_f32_16x16x32_bf16 v[56:59], v[224:227], v[152:155], v[56:59]
    buffer_load_dwordx4 v[204:207], v9, s[60:63], s83 offen offset:2048 sc1
    v_mfma_f32_16x16x32_bf16 v[60:63], v[228:231], v[140:143], v[60:63]
    ds_read_b128 v[188:191], v3 offset:8192
    v_mfma_f32_16x16x32_bf16 v[64:67], v[228:231], v[144:147], v[64:67]
    buffer_load_dwordx4 v[136:139], v9, s[60:63], s76 offen offset:3072 sc1
    v_mfma_f32_16x16x32_bf16 v[68:71], v[228:231], v[148:151], v[68:71]
    v_mfma_f32_16x16x32_bf16 v[72:75], v[228:231], v[152:155], v[72:75]
    buffer_load_dwordx4 v[208:211], v9, s[60:63], s83 offen offset:3072 sc1
    v_mfma_f32_16x16x32_bf16 v[76:79], v[232:235], v[140:143], v[76:79]
    ds_read_b128 v[192:195], v3 offset:9216
    s_add_u32 s83, s83, 4096
    s_add_u32 s76, s76, 4096
    v_mfma_f32_16x16x32_bf16 v[80:83], v[232:235], v[144:147], v[80:83]
    v_mfma_f32_16x16x32_bf16 v[84:87], v[232:235], v[148:151], v[84:87]
    s_cmp_eq_u32 s76, s77
    s_cselect_b32 s76, s82, s76
    v_mfma_f32_16x16x32_bf16 v[88:91], v[232:235], v[152:155], v[88:91]
    buffer_load_dwordx4 v[212:215], v9, s[60:63], s83 offen offset:0 sc1
    s_waitcnt vmcnt(13)
    v_mfma_f32_16x16x32_bf16 v[12:15], v[236:239], v[92:95], v[12:15]
    v_mfma_f32_16x16x32_bf16 v[16:19], v[236:239], v[96:99], v[16:19]
    buffer_load_dwordx4 v[140:143], v9, s[60:63], s76 offen offset:0 sc1
    v_mfma_f32_16x16x32_bf16 v[20:23], v[236:239], v[100:103], v[20:23]
    v_mfma_f32_16x16x32_bf16 v[24:27], v[236:239], v[104:107], v[24:27]
    v_mfma_f32_16x16x32_bf16 v[28:31], v[240:243], v[92:95], v[28:31]
    v_mfma_f32_16x16x32_bf16 v[32:35], v[240:243], v[96:99], v[32:35]
    buffer_load_dwordx4 v[144:147], v9, s[60:63], s76 offen offset:1024 sc1
    v_mfma_f32_16x16x32_bf16 v[36:39], v[240:243], v[100:103], v[36:39]
    v_mfma_f32_16x16x32_bf16 v[40:43], v[240:243], v[104:107], v[40:43]
    v_mfma_f32_16x16x32_bf16 v[44:47], v[244:247], v[92:95], v[44:47]
    v_mfma_f32_16x16x32_bf16 v[48:51], v[244:247], v[96:99], v[48:51]
    buffer_load_dwordx4 v[148:151], v9, s[60:63], s76 offen offset:2048 sc1
    v_mfma_f32_16x16x32_bf16 v[52:55], v[244:247], v[100:103], v[52:55]
    v_mfma_f32_16x16x32_bf16 v[56:59], v[244:247], v[104:107], v[56:59]
    v_mfma_f32_16x16x32_bf16 v[60:63], v[248:251], v[92:95], v[60:63]
    v_mfma_f32_16x16x32_bf16 v[64:67], v[248:251], v[96:99], v[64:67]
    buffer_load_dwordx4 v[152:155], v9, s[60:63], s76 offen offset:3072 sc1
    v_mfma_f32_16x16x32_bf16 v[68:71], v[248:251], v[100:103], v[68:71]
    v_mfma_f32_16x16x32_bf16 v[72:75], v[248:251], v[104:107], v[72:75]
    v_mfma_f32_16x16x32_bf16 v[76:79], v[252:255], v[92:95], v[76:79]
    s_add_u32 s76, s76, 4096
    v_mfma_f32_16x16x32_bf16 v[80:83], v[252:255], v[96:99], v[80:83]
    v_mfma_f32_16x16x32_bf16 v[84:87], v[252:255], v[100:103], v[84:87]
    s_cmp_eq_u32 s76, s77
    s_cselect_b32 s76, s82, s76
    v_mfma_f32_16x16x32_bf16 v[88:91], v[252:255], v[104:107], v[88:91]
    s_waitcnt vmcnt(13) lgkmcnt(5)
    v_mfma_f32_16x16x32_bf16 v[12:15], v[156:159], v[108:111], v[12:15]
    ds_read_b128 v[216:219], v3 offset:10240
    s_add_u32 s85, s94, 9
    v_mfma_f32_16x16x32_bf16 v[16:19], v[156:159], v[112:115], v[16:19]
    buffer_load_dwordx4 v[92:95], v9, s[60:63], s76 offen offset:0 sc1
    s_cmp_ge_u32 s85, s95
    s_cselect_b32 s15, s95, 0
    v_mfma_f32_16x16x32_bf16 v[20:23], v[156:159], v[116:119], v[20:23]
    s_sub_u32 s85, s85, s15
    s_mul_i32 s85, s85, 5120
    s_add_u32 s83, s85, s81
    v_mfma_f32_16x16x32_bf16 v[24:27], v[156:159], v[120:123], v[24:27]
    buffer_load_dwordx4 v[236:239], v9, s[60:63], s83 offen offset:0 sc1
    v_mfma_f32_16x16x32_bf16 v[28:31], v[160:163], v[108:111], v[28:31]
    ds_read_b128 v[220:223], v3 offset:11264
    v_mfma_f32_16x16x32_bf16 v[32:35], v[160:163], v[112:115], v[32:35]
    buffer_load_dwordx4 v[96:99], v9, s[60:63], s76 offen offset:1024 sc1
    v_mfma_f32_16x16x32_bf16 v[36:39], v[160:163], v[116:119], v[36:39]
    v_mfma_f32_16x16x32_bf16 v[40:43], v[160:163], v[120:123], v[40:43]
    buffer_load_dwordx4 v[240:243], v9, s[60:63], s83 offen offset:1024 sc1
    v_mfma_f32_16x16x32_bf16 v[44:47], v[164:167], v[108:111], v[44:47]
    ds_read_b128 v[224:227], v3 offset:12288
    v_mfma_f32_16x16x32_bf16 v[48:51], v[164:167], v[112:115], v[48:51]
    buffer_load_dwordx4 v[100:103], v9, s[60:63], s76 offen offset:2048 sc1
    v_mfma_f32_16x16x32_bf16 v[52:55], v[164:167], v[116:119], v[52:55]
    v_mfma_f32_16x16x32_bf16 v[56:59], v[164:167], v[120:123], v[56:59]
    buffer_load_dwordx4 v[244:247], v9, s[60:63], s83 offen offset:2048 sc1
    v_mfma_f32_16x16x32_bf16 v[60:63], v[168:171], v[108:111], v[60:63]
    ds_read_b128 v[228:231], v3 offset:13312
    v_mfma_f32_16x16x32_bf16 v[64:67], v[168:171], v[112:115], v[64:67]
    buffer_load_dwordx4 v[104:107], v9, s[60:63], s76 offen offset:3072 sc1
    v_mfma_f32_16x16x32_bf16 v[68:71], v[168:171], v[116:119], v[68:71]
    v_mfma_f32_16x16x32_bf16 v[72:75], v[168:171], v[120:123], v[72:75]
    buffer_load_dwordx4 v[248:251], v9, s[60:63], s83 offen offset:3072 sc1
    v_mfma_f32_16x16x32_bf16 v[76:79], v[172:175], v[108:111], v[76:79]
    ds_read_b128 v[232:235], v3 offset:14336
    s_add_u32 s83, s83, 4096
    s_add_u32 s76, s76, 4096
    v_mfma_f32_16x16x32_bf16 v[80:83], v[172:175], v[112:115], v[80:83]
    v_mfma_f32_16x16x32_bf16 v[84:87], v[172:175], v[116:119], v[84:87]
    s_cmp_eq_u32 s76, s77
    s_cselect_b32 s76, s82, s76
    v_mfma_f32_16x16x32_bf16 v[88:91], v[172:175], v[120:123], v[88:91]
    buffer_load_dwordx4 v[252:255], v9, s[60:63], s83 offen offset:0 sc1
    s_waitcnt vmcnt(15) lgkmcnt(5)
    v_mfma_f32_16x16x32_bf16 v[12:15], v[176:179], v[124:127], v[12:15]
    v_mfma_f32_16x16x32_bf16 v[16:19], v[176:179], v[128:131], v[16:19]
    buffer_load_dwordx4 v[108:111], v9, s[60:63], s76 offen offset:0 sc1
    v_mfma_f32_16x16x32_bf16 v[20:23], v[176:179], v[132:135], v[20:23]
    v_mfma_f32_16x16x32_bf16 v[24:27], v[176:179], v[136:139], v[24:27]
    v_mfma_f32_16x16x32_bf16 v[28:31], v[180:183], v[124:127], v[28:31]
    v_mfma_f32_16x16x32_bf16 v[32:35], v[180:183], v[128:131], v[32:35]
    buffer_load_dwordx4 v[112:115], v9, s[60:63], s76 offen offset:1024 sc1
    v_mfma_f32_16x16x32_bf16 v[36:39], v[180:183], v[132:135], v[36:39]
    v_mfma_f32_16x16x32_bf16 v[40:43], v[180:183], v[136:139], v[40:43]
    v_mfma_f32_16x16x32_bf16 v[44:47], v[184:187], v[124:127], v[44:47]
    v_mfma_f32_16x16x32_bf16 v[48:51], v[184:187], v[128:131], v[48:51]
    buffer_load_dwordx4 v[116:119], v9, s[60:63], s76 offen offset:2048 sc1
    v_mfma_f32_16x16x32_bf16 v[52:55], v[184:187], v[132:135], v[52:55]
    v_mfma_f32_16x16x32_bf16 v[56:59], v[184:187], v[136:139], v[56:59]
    v_mfma_f32_16x16x32_bf16 v[60:63], v[188:191], v[124:127], v[60:63]
    v_mfma_f32_16x16x32_bf16 v[64:67], v[188:191], v[128:131], v[64:67]
    buffer_load_dwordx4 v[120:123], v9, s[60:63], s76 offen offset:3072 sc1
    v_mfma_f32_16x16x32_bf16 v[68:71], v[188:191], v[132:135], v[68:71]
    v_mfma_f32_16x16x32_bf16 v[72:75], v[188:191], v[136:139], v[72:75]
    v_mfma_f32_16x16x32_bf16 v[76:79], v[192:195], v[124:127], v[76:79]
    s_add_u32 s76, s76, 4096
    v_mfma_f32_16x16x32_bf16 v[80:83], v[192:195], v[128:131], v[80:83]
    v_mfma_f32_16x16x32_bf16 v[84:87], v[192:195], v[132:135], v[84:87]
    s_cmp_eq_u32 s76, s77
    s_cselect_b32 s76, s82, s76
    v_mfma_f32_16x16x32_bf16 v[88:91], v[192:195], v[136:139], v[88:91]
    s_waitcnt vmcnt(13)
    v_mfma_f32_16x16x32_bf16 v[12:15], v[196:199], v[140:143], v[12:15]
    ds_read_b128 v[156:159], v3 offset:15360
    s_add_u32 s85, s94, 11
    v_mfma_f32_16x16x32_bf16 v[16:19], v[196:199], v[144:147], v[16:19]
    buffer_load_dwordx4 v[124:127], v9, s[60:63], s76 offen offset:0 sc1
    s_cmp_ge_u32 s85, s95
    s_cselect_b32 s15, s95, 0
    v_mfma_f32_16x16x32_bf16 v[20:23], v[196:199], v[148:151], v[20:23]
    s_sub_u32 s85, s85, s15
    s_mul_i32 s85, s85, 5120
    s_add_u32 s83, s85, s81
    v_mfma_f32_16x16x32_bf16 v[24:27], v[196:199], v[152:155], v[24:27]
    buffer_load_dwordx4 v[176:179], v9, s[60:63], s83 offen offset:0 sc1
    v_mfma_f32_16x16x32_bf16 v[28:31], v[200:203], v[140:143], v[28:31]
    ds_read_b128 v[160:163], v3 offset:16384
    v_mfma_f32_16x16x32_bf16 v[32:35], v[200:203], v[144:147], v[32:35]
    buffer_load_dwordx4 v[128:131], v9, s[60:63], s76 offen offset:1024 sc1
    v_mfma_f32_16x16x32_bf16 v[36:39], v[200:203], v[148:151], v[36:39]
    v_mfma_f32_16x16x32_bf16 v[40:43], v[200:203], v[152:155], v[40:43]
    buffer_load_dwordx4 v[180:183], v9, s[60:63], s83 offen offset:1024 sc1
    v_mfma_f32_16x16x32_bf16 v[44:47], v[204:207], v[140:143], v[44:47]
    ds_read_b128 v[164:167], v3 offset:17408
    v_mfma_f32_16x16x32_bf16 v[48:51], v[204:207], v[144:147], v[48:51]
    buffer_load_dwordx4 v[132:135], v9, s[60:63], s76 offen offset:2048 sc1
    v_mfma_f32_16x16x32_bf16 v[52:55], v[204:207], v[148:151], v[52:55]
    v_mfma_f32_16x16x32_bf16 v[56:59], v[204:207], v[152:155], v[56:59]
    buffer_load_dwordx4 v[184:187], v9, s[60:63], s83 offen offset:2048 sc1
    v_mfma_f32_16x16x32_bf16 v[60:63], v[208:211], v[140:143], v[60:63]
    ds_read_b128 v[168:171], v3 offset:18432
    v_mfma_f32_16x16x32_bf16 v[64:67], v[208:211], v[144:147], v[64:67]
    buffer_load_dwordx4 v[136:139], v9, s[60:63], s76 offen offset:3072 sc1
    v_mfma_f32_16x16x32_bf16 v[68:71], v[208:211], v[148:151], v[68:71]
    v_mfma_f32_16x16x32_bf16 v[72:75], v[208:211], v[152:155], v[72:75]
    buffer_load_dwordx4 v[188:191], v9, s[60:63], s83 offen offset:3072 sc1
    v_mfma_f32_16x16x32_bf16 v[76:79], v[212:215], v[140:143], v[76:79]
    ds_read_b128 v[172:175], v3 offset:19456
    s_add_u32 s83, s83, 4096
    s_add_u32 s76, s76, 4096
    v_mfma_f32_16x16x32_bf16 v[80:83], v[212:215], v[144:147], v[80:83]
    v_mfma_f32_16x16x32_bf16 v[84:87], v[212:215], v[148:151], v[84:87]
    s_cmp_eq_u32 s76, s77
    s_cselect_b32 s76, s82, s76
    v_mfma_f32_16x16x32_bf16 v[88:91], v[212:215], v[152:155], v[88:91]
    buffer_load_dwordx4 v[192:195], v9, s[60:63], s83 offen offset:0 sc1
    s_waitcnt vmcnt(15) lgkmcnt(5)
    v_mfma_f32_16x16x32_bf16 v[12:15], v[216:219], v[92:95], v[12:15]
    v_mfma_f32_16x16x32_bf16 v[16:19], v[216:219], v[96:99], v[16:19]
    buffer_load_dwordx4 v[140:143], v9, s[60:63], s76 offen offset:0 sc1
    v_mfma_f32_16x16x32_bf16 v[20:23], v[216:219], v[100:103], v[20:23]
    v_mfma_f32_16x16x32_bf16 v[24:27], v[216:219], v[104:107], v[24:27]
    v_mfma_f32_16x16x32_bf16 v[28:31], v[220:223], v[92:95], v[28:31]
    v_mfma_f32_16x16x32_bf16 v[32:35], v[220:223], v[96:99], v[32:35]
    buffer_load_dwordx4 v[144:147], v9, s[60:63], s76 offen offset:1024 sc1
    v_mfma_f32_16x16x32_bf16 v[36:39], v[220:223], v[100:103], v[36:39]
    v_mfma_f32_16x16x32_bf16 v[40:43], v[220:223], v[104:107], v[40:43]
    v_mfma_f32_16x16x32_bf16 v[44:47], v[224:227], v[92:95], v[44:47]
    v_mfma_f32_16x16x32_bf16 v[48:51], v[224:227], v[96:99], v[48:51]
    buffer_load_dwordx4 v[148:151], v9, s[60:63], s76 offen offset:2048 sc1
    v_mfma_f32_16x16x32_bf16 v[52:55], v[224:227], v[100:103], v[52:55]
    v_mfma_f32_16x16x32_bf16 v[56:59], v[224:227], v[104:107], v[56:59]
    v_mfma_f32_16x16x32_bf16 v[60:63], v[228:231], v[92:95], v[60:63]
    v_mfma_f32_16x16x32_bf16 v[64:67], v[228:231], v[96:99], v[64:67]
    buffer_load_dwordx4 v[152:155], v9, s[60:63], s76 offen offset:3072 sc1
    v_mfma_f32_16x16x32_bf16 v[68:71], v[228:231], v[100:103], v[68:71]
    v_mfma_f32_16x16x32_bf16 v[72:75], v[228:231], v[104:107], v[72:75]
    v_mfma_f32_16x16x32_bf16 v[76:79], v[232:235], v[92:95], v[76:79]
    s_add_u32 s76, s76, 4096
    v_mfma_f32_16x16x32_bf16 v[80:83], v[232:235], v[96:99], v[80:83]
    v_mfma_f32_16x16x32_bf16 v[84:87], v[232:235], v[100:103], v[84:87]
    s_cmp_eq_u32 s76, s77
    s_cselect_b32 s76, s82, s76
    v_mfma_f32_16x16x32_bf16 v[88:91], v[232:235], v[104:107], v[88:91]
    buffer_load_dwordx2 v[6:7], v10, s[60:63], 0 offen sc1
    s_waitcnt vmcnt(14)
    v_mfma_f32_16x16x32_bf16 v[12:15], v[236:239], v[108:111], v[12:15]
    ds_read_b128 v[196:199], v3 offset:20480
    s_add_u32 s85, s94, 13
    v_mfma_f32_16x16x32_bf16 v[16:19], v[236:239], v[112:115], v[16:19]
    buffer_load_dwordx4 v[92:95], v9, s[60:63], s76 offen offset:0 sc1
    s_cmp_ge_u32 s85, s95
    s_cselect_b32 s15, s95, 0
    v_mfma_f32_16x16x32_bf16 v[20:23], v[236:239], v[116:119], v[20:23]
    s_sub_u32 s85, s85, s15
    s_mul_i32 s85, s85, 5120
    s_add_u32 s83, s85, s81
    v_mfma_f32_16x16x32_bf16 v[24:27], v[236:239], v[120:123], v[24:27]
    buffer_load_dwordx4 v[216:219], v0, s[60:63], s83 offen offset:0 sc1
    v_mfma_f32_16x16x32_bf16 v[28:31], v[240:243], v[108:111], v[28:31]
    ds_read_b128 v[200:203], v3 offset:21504
    v_mfma_f32_16x16x32_bf16 v[32:35], v[240:243], v[112:115], v[32:35]
    buffer_load_dwordx4 v[96:99], v9, s[60:63], s76 offen offset:1024 sc1
    v_mfma_f32_16x16x32_bf16 v[36:39], v[240:243], v[116:119], v[36:39]
    v_mfma_f32_16x16x32_bf16 v[40:43], v[240:243], v[120:123], v[40:43]
    buffer_load_dwordx4 v[220:223], v0, s[60:63], s83 offen offset:1024 sc1
    v_mfma_f32_16x16x32_bf16 v[44:47], v[244:247], v[108:111], v[44:47]
    ds_read_b128 v[204:207], v3 offset:22528
    v_mfma_f32_16x16x32_bf16 v[48:51], v[244:247], v[112:115], v[48:51]
    buffer_load_dwordx4 v[100:103], v9, s[60:63], s76 offen offset:2048 sc1
    v_mfma_f32_16x16x32_bf16 v[52:55], v[244:247], v[116:119], v[52:55]
    v_mfma_f32_16x16x32_bf16 v[56:59], v[244:247], v[120:123], v[56:59]
    buffer_load_dwordx4 v[224:227], v0, s[60:63], s83 offen offset:2048 sc1
    v_mfma_f32_16x16x32_bf16 v[60:63], v[248:251], v[108:111], v[60:63]
    ds_read_b128 v[208:211], v3 offset:23552
    v_mfma_f32_16x16x32_bf16 v[64:67], v[248:251], v[112:115], v[64:67]
    buffer_load_dwordx4 v[104:107], v9, s[60:63], s76 offen offset:3072 sc1
    v_mfma_f32_16x16x32_bf16 v[68:71], v[248:251], v[116:119], v[68:71]
    v_mfma_f32_16x16x32_bf16 v[72:75], v[248:251], v[120:123], v[72:75]
    buffer_load_dwordx4 v[228:231], v0, s[60:63], s83 offen offset:3072 sc1
    v_mfma_f32_16x16x32_bf16 v[76:79], v[252:255], v[108:111], v[76:79]
    ds_read_b128 v[212:215], v3 offset:24576
    s_add_u32 s83, s83, 4096
    s_add_u32 s76, s76, 4096
    v_mfma_f32_16x16x32_bf16 v[80:83], v[252:255], v[112:115], v[80:83]
    v_mfma_f32_16x16x32_bf16 v[84:87], v[252:255], v[116:119], v[84:87]
    s_cmp_eq_u32 s76, s77
    s_cselect_b32 s76, s82, s76
    v_mfma_f32_16x16x32_bf16 v[88:91], v[252:255], v[120:123], v[88:91]
    buffer_load_dwordx4 v[232:235], v0, s[60:63], s83 offen offset:0 sc1
    s_waitcnt vmcnt(16) lgkmcnt(5)
    v_mfma_f32_16x16x32_bf16 v[12:15], v[156:159], v[124:127], v[12:15]
    v_lshrrev_b32 v2, 5, v1
    v_mfma_f32_16x16x32_bf16 v[16:19], v[156:159], v[128:131], v[16:19]
    buffer_load_dwordx4 v[108:111], v0, s[60:63], s76 offen offset:0 sc1
    v_mfma_f32_16x16x32_bf16 v[20:23], v[156:159], v[132:135], v[20:23]
    v_lshlrev_b32 v2, 16, v2
    v_mfma_f32_16x16x32_bf16 v[24:27], v[156:159], v[136:139], v[24:27]
    v_bfe_u32 v252, v1, 3, 2
    v_mfma_f32_16x16x32_bf16 v[28:31], v[160:163], v[124:127], v[28:31]
    v_lshl_add_u32 v2, v252, 12, v2
    v_mfma_f32_16x16x32_bf16 v[32:35], v[160:163], v[128:131], v[32:35]
    buffer_load_dwordx4 v[112:115], v0, s[60:63], s76 offen offset:1024 sc1
    v_mfma_f32_16x16x32_bf16 v[36:39], v[160:163], v[132:135], v[36:39]
    v_and_b32 v252, 7, v1
    v_mfma_f32_16x16x32_bf16 v[40:43], v[160:163], v[136:139], v[40:43]
    v_lshl_add_u32 v252, v252, 4, v2
    v_mfma_f32_16x16x32_bf16 v[44:47], v[164:167], v[124:127], v[44:47]
    v_and_b32 v240, 15, v1
    v_mfma_f32_16x16x32_bf16 v[48:51], v[164:167], v[128:131], v[48:51]
    buffer_load_dwordx4 v[116:119], v0, s[60:63], s76 offen offset:2048 sc1
    v_mfma_f32_16x16x32_bf16 v[52:55], v[164:167], v[132:135], v[52:55]
    v_lshlrev_b32 v253, 2, v240
    v_mfma_f32_16x16x32_bf16 v[56:59], v[164:167], v[136:139], v[56:59]
    v_lshrrev_b32 v2, 4, v1
    v_mfma_f32_16x16x32_bf16 v[60:63], v[168:171], v[124:127], v[60:63]
    v_mul_u32_u24 v239, 25600, v2
    v_mfma_f32_16x16x32_bf16 v[64:67], v[168:171], v[128:131], v[64:67]
    buffer_load_dwordx4 v[120:123], v0, s[60:63], s76 offen offset:3072 sc1
    v_mfma_f32_16x16x32_bf16 v[68:71], v[168:171], v[132:135], v[68:71]
    v_bfe_u32 v241, v1, 2, 2
    v_mfma_f32_16x16x32_bf16 v[72:75], v[168:171], v[136:139], v[72:75]
    v_lshl_add_u32 v239, v241, 7, v239
    v_mfma_f32_16x16x32_bf16 v[76:79], v[172:175], v[124:127], v[76:79]
    s_add_u32 s76, s76, 4096
    v_and_b32 v241, 3, v1
    v_mfma_f32_16x16x32_bf16 v[80:83], v[172:175], v[128:131], v[80:83]
    v_mfma_f32_16x16x32_bf16 v[84:87], v[172:175], v[132:135], v[84:87]
    s_cmp_eq_u32 s76, s77
    s_cselect_b32 s76, s82, s76
    v_lshl_add_u32 v239, v241, 3, v239
    v_mfma_f32_16x16x32_bf16 v[88:91], v[172:175], v[136:139], v[88:91]
    s_waitcnt vmcnt(14)
    s_waitcnt vmcnt(13) lgkmcnt(0)
    v_cmp_eq_u64 vcc, v[4:5], v[6:7]
    v_mfma_f32_16x16x32_bf16 v[12:15], v[176:179], v[140:143], v[12:15]
    s_cmp_eq_u64 vcc, -1
    s_cselect_b32 s14, 1, 0
    s_sub_u32 s11, s3, 1
    s_and_b32 s11, s11, 3
    v_mfma_f32_16x16x32_bf16 v[16:19], v[176:179], v[144:147], v[16:19]
    s_add_u32 m0, s84, 15360
    s_add_u32 s10, s12, 130048
    buffer_load_dwordx4 v252, s[60:63], s12 offen sc1 lds
    s_mul_i32 s11, s11, 25600
    v_mfma_f32_16x16x32_bf16 v[20:23], v[176:179], v[148:151], v[20:23]
    v_add_u32 v236, s11, v9
    s_sub_u32 s11, s3, 2
    v_mfma_f32_16x16x32_bf16 v[24:27], v[176:179], v[152:155], v[24:27]
    s_and_b32 s11, s11, 3
    s_mul_i32 s11, s11, 25600
    v_mfma_f32_16x16x32_bf16 v[28:31], v[180:183], v[140:143], v[28:31]
    v_add_u32 v237, s11, v9
    s_sub_u32 s11, s3, 3
    v_mfma_f32_16x16x32_bf16 v[32:35], v[180:183], v[144:147], v[32:35]
    buffer_load_dwordx4 v252, s[60:63], s10 offen offset:1024 sc1 lds
    s_add_u32 s10, s12, 260096
    s_and_b32 s11, s11, 3
    v_mfma_f32_16x16x32_bf16 v[36:39], v[180:183], v[148:151], v[36:39]
    s_mul_i32 s11, s11, 25600
    v_mfma_f32_16x16x32_bf16 v[40:43], v[180:183], v[152:155], v[40:43]
    v_add_u32 v238, s11, v9
    v_mfma_f32_16x16x32_bf16 v[44:47], v[184:187], v[140:143], v[44:47]
    s_lshl_b32 s11, s3, 5
    v_mfma_f32_16x16x32_bf16 v[48:51], v[184:187], v[144:147], v[48:51]
    s_mov_b64 exec, 0xffffffff
    buffer_load_dwordx4 v252, s[60:63], s10 offen offset:2048 sc1 lds
    s_mov_b64 exec, -1
    v_mfma_f32_16x16x32_bf16 v[52:55], v[184:187], v[148:151], v[52:55]
    v_add_u32 v239, s11, v239
    v_mfma_f32_16x16x32_bf16 v[56:59], v[184:187], v[152:155], v[56:59]
    v_mul_u32_u24 v240, 160, v240
    v_mfma_f32_16x16x32_bf16 v[60:63], v[188:191], v[140:143], v[60:63]
    v_lshl_add_u32 v240, v2, 3, v240
    v_mfma_f32_16x16x32_bf16 v[64:67], v[188:191], v[144:147], v[64:67]
    buffer_load_dword v8, v253, s[60:63], s80 offen sc1
    v_mfma_f32_16x16x32_bf16 v[68:71], v[188:191], v[148:151], v[68:71]
    v_add_u32 v240, s84, v240
    v_mfma_f32_16x16x32_bf16 v[72:75], v[188:191], v[152:155], v[72:75]
    s_mul_i32 s78, s5, 160
    v_mfma_f32_16x16x32_bf16 v[76:79], v[192:195], v[140:143], v[76:79]
    s_mul_i32 s11, s13, 20480
    v_mfma_f32_16x16x32_bf16 v[80:83], v[192:195], v[144:147], v[80:83]
    v_mfma_f32_16x16x32_bf16 v[84:87], v[192:195], v[148:151], v[84:87]
    s_add_u32 s78, s78, s11
    v_mfma_f32_16x16x32_bf16 v[88:91], v[192:195], v[152:155], v[88:91]
    s_waitcnt vmcnt(10)
    s_waitcnt vmcnt(4)
    v_mfma_f32_16x16x32_bf16 v[12:15], v[196:199], v[92:95], v[12:15]
    v_mfma_f32_16x16x32_bf16 v[28:31], v[200:203], v[92:95], v[28:31]
    v_mfma_f32_16x16x32_bf16 v[44:47], v[204:207], v[92:95], v[44:47]
    v_mfma_f32_16x16x32_bf16 v[60:63], v[208:211], v[92:95], v[60:63]
    v_mfma_f32_16x16x32_bf16 v[76:79], v[212:215], v[92:95], v[76:79]
    v_mfma_f32_16x16x32_bf16 v[12:15], v[216:219], v[108:111], v[12:15]
    v_mfma_f32_16x16x32_bf16 v[28:31], v[220:223], v[108:111], v[28:31]
    v_mfma_f32_16x16x32_bf16 v[44:47], v[224:227], v[108:111], v[44:47]
    v_mfma_f32_16x16x32_bf16 v[60:63], v[228:231], v[108:111], v[60:63]
    v_mfma_f32_16x16x32_bf16 v[76:79], v[232:235], v[108:111], v[76:79]
    v_mfma_f32_16x16x32_bf16 v[16:19], v[196:199], v[96:99], v[16:19]
    v_mfma_f32_16x16x32_bf16 v[32:35], v[200:203], v[96:99], v[32:35]
    v_mfma_f32_16x16x32_bf16 v[48:51], v[204:207], v[96:99], v[48:51]
    v_mfma_f32_16x16x32_bf16 v[64:67], v[208:211], v[96:99], v[64:67]
    ds_write_b128 v3, v[12:15] offset:0
    v_mfma_f32_16x16x32_bf16 v[80:83], v[212:215], v[96:99], v[80:83]
    v_mfma_f32_16x16x32_bf16 v[16:19], v[216:219], v[112:115], v[16:19]
    ds_write_b128 v3, v[28:31] offset:1024
    v_mfma_f32_16x16x32_bf16 v[32:35], v[220:223], v[112:115], v[32:35]
    v_mfma_f32_16x16x32_bf16 v[48:51], v[224:227], v[112:115], v[48:51]
    ds_write_b128 v3, v[44:47] offset:2048
    v_mfma_f32_16x16x32_bf16 v[64:67], v[228:231], v[112:115], v[64:67]
    v_mfma_f32_16x16x32_bf16 v[80:83], v[232:235], v[112:115], v[80:83]
    ds_write_b128 v3, v[60:63] offset:3072
    ds_write_b128 v3, v[76:79] offset:4096
    v_mfma_f32_16x16x32_bf16 v[20:23], v[196:199], v[100:103], v[20:23]
    v_mfma_f32_16x16x32_bf16 v[36:39], v[200:203], v[100:103], v[36:39]
    v_mfma_f32_16x16x32_bf16 v[52:55], v[204:207], v[100:103], v[52:55]
    v_mfma_f32_16x16x32_bf16 v[68:71], v[208:211], v[100:103], v[68:71]
    ds_write_b128 v3, v[16:19] offset:5120
    v_mfma_f32_16x16x32_bf16 v[84:87], v[212:215], v[100:103], v[84:87]
    v_mfma_f32_16x16x32_bf16 v[20:23], v[216:219], v[116:119], v[20:23]
    ds_write_b128 v3, v[32:35] offset:6144
    v_mfma_f32_16x16x32_bf16 v[36:39], v[220:223], v[116:119], v[36:39]
    v_mfma_f32_16x16x32_bf16 v[52:55], v[224:227], v[116:119], v[52:55]
    ds_write_b128 v3, v[48:51] offset:7168
    v_mfma_f32_16x16x32_bf16 v[68:71], v[228:231], v[116:119], v[68:71]
    v_mfma_f32_16x16x32_bf16 v[84:87], v[232:235], v[116:119], v[84:87]
    ds_write_b128 v3, v[64:67] offset:8192
    ds_write_b128 v3, v[80:83] offset:9216
    v_mfma_f32_16x16x32_bf16 v[24:27], v[196:199], v[104:107], v[24:27]
    v_mfma_f32_16x16x32_bf16 v[40:43], v[200:203], v[104:107], v[40:43]
    v_mfma_f32_16x16x32_bf16 v[56:59], v[204:207], v[104:107], v[56:59]
    v_mfma_f32_16x16x32_bf16 v[72:75], v[208:211], v[104:107], v[72:75]
    ds_write_b128 v3, v[20:23] offset:10240
    v_mfma_f32_16x16x32_bf16 v[88:91], v[212:215], v[104:107], v[88:91]
    v_mfma_f32_16x16x32_bf16 v[24:27], v[216:219], v[120:123], v[24:27]
    ds_write_b128 v3, v[36:39] offset:11264
    v_mfma_f32_16x16x32_bf16 v[40:43], v[220:223], v[120:123], v[40:43]
    v_mfma_f32_16x16x32_bf16 v[56:59], v[224:227], v[120:123], v[56:59]
    ds_write_b128 v3, v[52:55] offset:12288
    v_mfma_f32_16x16x32_bf16 v[72:75], v[228:231], v[120:123], v[72:75]
    v_mfma_f32_16x16x32_bf16 v[88:91], v[232:235], v[120:123], v[88:91]
    ds_write_b128 v3, v[68:71] offset:13312
    ds_write_b128 v3, v[84:87] offset:14336
    s_cmp_eq_u32 s14, 1
    s_cbranch_scc1 L_aok
    s_waitcnt vmcnt(0)
    v_cmp_eq_u64 vcc, v[4:5], v[6:7]
    s_nop 0
    s_cmp_eq_u64 vcc, -1
    s_cbranch_scc0 L_fl_11
L_fd_12:
    s_add_u32 m0, s84, 15360
    s_add_u32 s10, s12, 130048
    buffer_load_dwordx4 v252, s[60:63], s12 offen sc1 lds
    buffer_load_dwordx4 v252, s[60:63], s10 offen offset:1024 sc1 lds
    s_add_u32 s10, s12, 260096
    s_mov_b64 exec, 0xffffffff
    buffer_load_dwordx4 v252, s[60:63], s10 offen offset:2048 sc1 lds
    s_mov_b64 exec, -1
    buffer_load_dword v8, v253, s[60:63], s80 offen sc1
L_aok:
    v_add_u32 v2, 0, v1
    v_mul_u32_u24 v156, 6554, v2
    v_lshrrev_b32 v156, 16, v156
    v_mul_u32_u24 v156, 1120, v156
    v_lshl_add_u32 v156, v2, 4, v156
    v_add_u32 v2, 64, v1
    v_mul_u32_u24 v157, 6554, v2
    v_lshrrev_b32 v157, 16, v157
    v_mul_u32_u24 v157, 1120, v157
    v_lshl_add_u32 v157, v2, 4, v157
    v_add_u32 v2, 128, v1
    v_mul_u32_u24 v158, 6554, v2
    v_lshrrev_b32 v158, 16, v158
    v_mul_u32_u24 v158, 1120, v158
    v_lshl_add_u32 v158, v2, 4, v158
    s_waitcnt vmcnt(0) lgkmcnt(0)
    s_barrier
    ds_read_b128 v[92:95], v236 offset:0
    ds_read_b128 v[96:99], v236 offset:1024
    ds_read_b128 v[100:103], v236 offset:2048
    ds_read_b128 v[104:107], v236 offset:3072
    ds_read_b128 v[108:111], v236 offset:4096
    ds_read_b128 v[112:115], v237 offset:5120
    ds_read_b128 v[116:119], v237 offset:6144
    ds_read_b128 v[120:123], v237 offset:7168
    ds_read_b128 v[124:127], v237 offset:8192
    ds_read_b128 v[128:131], v237 offset:9216
    ds_read_b128 v[132:135], v238 offset:10240
    ds_read_b128 v[136:139], v238 offset:11264
    ds_read_b128 v[140:143], v238 offset:12288
    ds_read_b128 v[144:147], v238 offset:13312
    ds_read_b128 v[148:151], v238 offset:14336
    v_sub_f32 v241, 1.0, v8
    v_cvt_pk_bf16_f32 v241, v241, v241
    v_lshlrev_b32 v241, 16, v241
    s_waitcnt lgkmcnt(10)
    ds_read_b64_tr_b16 v[242:243], v239 offset:15360
    ds_read_b64_tr_b16 v[244:245], v239 offset:15872
    ds_read_b64_tr_b16 v[246:247], v239 offset:16384
    ds_read_b64_tr_b16 v[248:249], v239 offset:16896
    ds_read_b64_tr_b16 v[250:251], v239 offset:17408
    v_pk_add_f32 v[24:25], v[24:25], v[92:93]
    v_pk_add_f32 v[26:27], v[26:27], v[94:95]
    v_pk_add_f32 v[40:41], v[40:41], v[96:97]
    v_pk_add_f32 v[42:43], v[42:43], v[98:99]
    v_pk_add_f32 v[56:57], v[56:57], v[100:101]
    v_pk_add_f32 v[58:59], v[58:59], v[102:103]
    v_pk_add_f32 v[72:73], v[72:73], v[104:105]
    v_pk_add_f32 v[74:75], v[74:75], v[106:107]
    v_pk_add_f32 v[88:89], v[88:89], v[108:109]
    v_pk_add_f32 v[90:91], v[90:91], v[110:111]
    s_waitcnt lgkmcnt(10)
    v_pk_add_f32 v[24:25], v[24:25], v[112:113]
    v_pk_add_f32 v[26:27], v[26:27], v[114:115]
    v_pk_add_f32 v[40:41], v[40:41], v[116:117]
    v_pk_add_f32 v[42:43], v[42:43], v[118:119]
    v_pk_add_f32 v[56:57], v[56:57], v[120:121]
    v_pk_add_f32 v[58:59], v[58:59], v[122:123]
    v_pk_add_f32 v[72:73], v[72:73], v[124:125]
    v_pk_add_f32 v[74:75], v[74:75], v[126:127]
    v_pk_add_f32 v[88:89], v[88:89], v[128:129]
    v_pk_add_f32 v[90:91], v[90:91], v[130:131]
    s_waitcnt lgkmcnt(5)
    v_pk_add_f32 v[24:25], v[24:25], v[132:133]
    v_pk_add_f32 v[26:27], v[26:27], v[134:135]
    v_pk_add_f32 v[40:41], v[40:41], v[136:137]
    v_pk_add_f32 v[42:43], v[42:43], v[138:139]
    v_pk_add_f32 v[56:57], v[56:57], v[140:141]
    v_pk_add_f32 v[58:59], v[58:59], v[142:143]
    v_pk_add_f32 v[72:73], v[72:73], v[144:145]
    v_pk_add_f32 v[74:75], v[74:75], v[146:147]
    v_pk_add_f32 v[88:89], v[88:89], v[148:149]
    v_pk_add_f32 v[90:91], v[90:91], v[150:151]
    s_waitcnt lgkmcnt(0)
    v_lshlrev_b32 v92, 16, v242
    v_and_b32 v93, 0xffff0000, v242
    v_lshlrev_b32 v94, 16, v243
    v_and_b32 v95, 0xffff0000, v243
    v_mul_f32 v92, v8, v92
    v_mul_f32 v93, v8, v93
    v_mul_f32 v94, v8, v94
    v_mul_f32 v95, v8, v95
    v_fmac_f32 v92, v241, v24
    v_fmac_f32 v93, v241, v25
    v_fmac_f32 v94, v241, v26
    v_fmac_f32 v95, v241, v27
    v_cvt_pk_bf16_f32 v242, v92, v93
    v_cvt_pk_bf16_f32 v243, v94, v95
    ds_write_b64 v240, v[242:243] offset:20480
    v_lshlrev_b32 v96, 16, v244
    v_and_b32 v97, 0xffff0000, v244
    v_lshlrev_b32 v98, 16, v245
    v_and_b32 v99, 0xffff0000, v245
    v_mul_f32 v96, v8, v96
    v_mul_f32 v97, v8, v97
    v_mul_f32 v98, v8, v98
    v_mul_f32 v99, v8, v99
    v_fmac_f32 v96, v241, v40
    v_fmac_f32 v97, v241, v41
    v_fmac_f32 v98, v241, v42
    v_fmac_f32 v99, v241, v43
    v_cvt_pk_bf16_f32 v244, v96, v97
    v_cvt_pk_bf16_f32 v245, v98, v99
    ds_write_b64 v240, v[244:245] offset:20512
    v_lshlrev_b32 v100, 16, v246
    v_and_b32 v101, 0xffff0000, v246
    v_lshlrev_b32 v102, 16, v247
    v_and_b32 v103, 0xffff0000, v247
    v_mul_f32 v100, v8, v100
    v_mul_f32 v101, v8, v101
    v_mul_f32 v102, v8, v102
    v_mul_f32 v103, v8, v103
    v_fmac_f32 v100, v241, v56
    v_fmac_f32 v101, v241, v57
    v_fmac_f32 v102, v241, v58
    v_fmac_f32 v103, v241, v59
    v_cvt_pk_bf16_f32 v246, v100, v101
    v_cvt_pk_bf16_f32 v247, v102, v103
    ds_write_b64 v240, v[246:247] offset:20544
    v_lshlrev_b32 v104, 16, v248
    v_and_b32 v105, 0xffff0000, v248
    v_lshlrev_b32 v106, 16, v249
    v_and_b32 v107, 0xffff0000, v249
    v_mul_f32 v104, v8, v104
    v_mul_f32 v105, v8, v105
    v_mul_f32 v106, v8, v106
    v_mul_f32 v107, v8, v107
    v_fmac_f32 v104, v241, v72
    v_fmac_f32 v105, v241, v73
    v_fmac_f32 v106, v241, v74
    v_fmac_f32 v107, v241, v75
    v_cvt_pk_bf16_f32 v248, v104, v105
    v_cvt_pk_bf16_f32 v249, v106, v107
    ds_write_b64 v240, v[248:249] offset:20576
    v_lshlrev_b32 v108, 16, v250
    v_and_b32 v109, 0xffff0000, v250
    v_lshlrev_b32 v110, 16, v251
    v_and_b32 v111, 0xffff0000, v251
    v_mul_f32 v108, v8, v108
    v_mul_f32 v109, v8, v109
    v_mul_f32 v110, v8, v110
    v_mul_f32 v111, v8, v111
    v_fmac_f32 v108, v241, v88
    v_fmac_f32 v109, v241, v89
    v_fmac_f32 v110, v241, v90
    v_fmac_f32 v111, v241, v91
    v_cvt_pk_bf16_f32 v250, v108, v109
    v_cvt_pk_bf16_f32 v251, v110, v111
    ds_write_b64 v240, v[250:251] offset:20608
    ds_read_b128 v[116:119], v3 offset:20480
    ds_read_b128 v[120:123], v3 offset:21504
    ds_read_b128 v[124:127], v3 offset:22528
    s_waitcnt lgkmcnt(2)
    buffer_store_dwordx4 v[116:119], v156, s[64:67], s78 offen
    s_waitcnt lgkmcnt(1)
    buffer_store_dwordx4 v[120:123], v157, s[64:67], s78 offen
    s_waitcnt lgkmcnt(0)
    s_mov_b64 exec, 0xffffffff
    buffer_store_dwordx4 v[124:127], v158, s[64:67], s78 offen
    s_mov_b64 exec, -1
L_end:
    s_endpgm
L_nl_2:
    s_mov_b32 s87, 0
L_nm_4:
    s_sleep 4
    buffer_load_dwordx2 v[4:5], v8, s[72:75], 0 offen sc1
    s_waitcnt vmcnt(0)
    v_min_u32 v2, v4, v5
    v_cmp_eq_u32 vcc, 0, v2
    s_cbranch_vccz L_nd_3
    s_add_u32 s87, s87, 1
    s_cmp_lt_u32 s87, 0x8000
    s_cbranch_scc1 L_nm_4
    s_branch L_nd_3
L_fl_5:
    s_mov_b32 s87, 0
L_fm_7:
    buffer_load_dwordx2 v[6:7], v10, s[60:63], 0 offen sc1
    s_waitcnt vmcnt(0)
    v_cmp_eq_u64 vcc, v[4:5], v[6:7]
    s_nop 0
    s_cmp_eq_u64 vcc, -1
    s_cbranch_scc1 L_fd_6
    s_sleep 8
    s_add_u32 s87, s87, 1
    s_cmp_lt_u32 s87, 0x8000
    s_cbranch_scc1 L_fm_7
    s_branch L_fd_6
L_fl_8:
    s_mov_b32 s87, 0
L_fm_10:
    buffer_load_dwordx2 v[6:7], v10, s[60:63], 0 offen sc1
    s_waitcnt vmcnt(0)
    v_cmp_eq_u64 vcc, v[4:5], v[6:7]
    s_nop 0
    s_cmp_eq_u64 vcc, -1
    s_cbranch_scc1 L_fd_9
    s_sleep 8
    s_add_u32 s87, s87, 1
    s_cmp_lt_u32 s87, 0x8000
    s_cbranch_scc1 L_fm_10
    s_branch L_fd_9
L_fl_11:
    s_mov_b32 s87, 0
L_fm_13:
    buffer_load_dwordx2 v[6:7], v10, s[60:63], 0 offen sc1
    s_waitcnt vmcnt(0)
    v_cmp_eq_u64 vcc, v[4:5], v[6:7]
    s_nop 0
    s_cmp_eq_u64 vcc, -1
    s_cbranch_scc1 L_fd_12
    s_sleep 8
    s_add_u32 s87, s87, 1
    s_cmp_lt_u32 s87, 0x8000
    s_cbranch_scc1 L_fm_13
    s_branch L_fd_12
L_s:
    s_setprio 0
    s_barrier
    s_setprio 3
    ds_read_b64_tr_b16 v[216:217], v237 offset:512
    ds_read_b64_tr_b16 v[218:219], v236
    ds_read_b64_tr_b16 v[220:221], v236 offset:512
    ds_read_b64_tr_b16 v[222:223], v237
    ds_read_b64_tr_b16 v[224:225], v239 offset:512
    ds_read_b64_tr_b16 v[226:227], v238
    ds_read_b64_tr_b16 v[228:229], v238 offset:512
    ds_read_b64_tr_b16 v[230:231], v239
    ds_read_b128 v[136:139], v14 offset:0
    ds_read_b128 v[140:143], v14 offset:1024
    ds_read_b128 v[144:147], v14 offset:2048
    s_waitcnt lgkmcnt(0)
    v_add_f32 v124, v124, v136
    v_add_f32 v125, v125, v137
    v_add_f32 v126, v126, v138
    v_add_f32 v127, v127, v139
    v_add_f32 v128, v128, v140
    v_add_f32 v129, v129, v141
    v_add_f32 v130, v130, v142
    v_add_f32 v131, v131, v143
    v_add_f32 v132, v132, v144
    v_add_f32 v133, v133, v145
    v_add_f32 v134, v134, v146
    ds_write_b128 v15, v[124:127]
    ds_write_b128 v16, v[128:131] offset:1024
    ds_write_b64 v17, v[132:133] offset:2048
    ds_write_b32 v18, v134 offset:2560
    s_barrier
    ds_read_b128 v[24:27], v19
    ds_read_b32 v28, v19 offset:16
    ds_read_b32 v29, v23
    ds_read_b64 v[30:31], v20 offset:1024
    ds_read_b32 v32, v20 offset:1032
    ds_read2_b32 v[34:35], v22 offset0:0 offset1:1
    ds_read2_b32 v[36:37], v22 offset0:64 offset1:65
    ds_read2_b32 v[38:39], v21 offset0:0 offset1:1
    ds_read2_b32 v[40:41], v21 offset0:32 offset1:33
    ds_read2_b32 v[42:43], v21 offset0:64 offset1:65
    ds_read2_b32 v[44:45], v21 offset0:96 offset1:97
    s_setprio 0
    s_setprio 3
    buffer_store_dwordx4 v[216:219], v232, s[60:63], s4 offen sc1
    s_add_u32 s4, s4, 0x10000
    buffer_store_dwordx4 v[220:223], v232, s[60:63], s4 offen sc1
    s_add_u32 s4, s4, 0x10000
    buffer_store_dwordx4 v[224:227], v232, s[60:63], s4 offen sc1
    s_add_u32 s4, s4, 0x10000
    buffer_store_dwordx4 v[228:231], v232, s[60:63], s4 offen sc1
    s_setprio 0
    s_barrier
    s_setprio 3
    buffer_load_dwordx2 v[4:5], v8, s[72:75], 0 offen sc1
    s_setprio 0
    s_barrier
    s_barrier
    v_and_b32 v2, 15, v1
    v_lshrrev_b32 v3, 4, v1
    v_lshlrev_b32 v16, 3, v3
    v_sub_u32 v16, v2, v16
    v_lshl_add_u32 v17, v16, 2, s5
    v_add_u32 v184, 100, v17
    v_add_u32 v185, 1124, v17
    v_add_u32 v186, 2148, v17
    v_add_u32 v187, 3172, v17
    v_add_u32 v188, 4196, v17
    v_add_u32 v189, 5220, v17
    v_add_u32 v190, 6244, v17
    v_add_u32 v191, 7268, v17
    v_lshl_add_u32 v17, v2, 1, v3
    s_barrier
    v_add_u32 v18, 14, v17
    v_lshrrev_b32 v19, 2, v18
    v_xor_b32 v19, s3, v19
    v_and_b32 v19, 3, v19
    v_lshlrev_b32 v19, 4, v19
    v_lshl_add_u32 v19, v18, 6, v19
    v_add_u32 v192, 106496, v19
    v_add_u32 v18, 10, v17
    v_lshrrev_b32 v19, 2, v18
    v_xor_b32 v19, s3, v19
    v_and_b32 v19, 3, v19
    v_lshlrev_b32 v19, 4, v19
    v_lshl_add_u32 v19, v18, 6, v19
    v_add_u32 v193, 106496, v19
    s_waitcnt vmcnt(0)
    v_min_u32 v2, v4, v5
    v_cmp_eq_u32 vcc, 0, v2
    s_cbranch_vccnz L_nl_14
L_nd_15:
    s_mov_b64 exec, 1
    s_setprio 3
    buffer_store_dwordx2 v[4:5], v8, s[60:63], s100 offen sc1
    s_setprio 0
    s_mov_b64 exec, -1
    s_barrier
    v_add_u32 v18, 6, v17
    v_lshrrev_b32 v19, 2, v18
    v_xor_b32 v19, s3, v19
    v_and_b32 v19, 3, v19
    v_lshlrev_b32 v19, 4, v19
    v_lshl_add_u32 v19, v18, 6, v19
    v_add_u32 v194, 106496, v19
    v_add_u32 v18, 2, v17
    v_lshrrev_b32 v19, 2, v18
    v_xor_b32 v19, s3, v19
    v_and_b32 v19, 3, v19
    v_lshlrev_b32 v19, 4, v19
    v_lshl_add_u32 v19, v18, 6, v19
    v_add_u32 v195, 106496, v19
    s_barrier
    v_sub_u32 v16, -9, v16
    v_and_b32 v18, 1, v16
    v_lshlrev_b32 v18, 4, v18
    v_mov_b32 v19, s83
    v_lshlrev_b32 v18, v18, v19
    v_ashrrev_i32 v16, 1, v16
    v_cmp_eq_u32 vcc, 0, v16
    s_nop 1
    v_cndmask_b32 v196, 0, v18, vcc
    v_cmp_eq_u32 vcc, 1, v16
    s_nop 1
    v_cndmask_b32 v197, 0, v18, vcc
    v_cmp_eq_u32 vcc, 2, v16
    s_nop 1
    v_cndmask_b32 v198, 0, v18, vcc
    v_cmp_eq_u32 vcc, 3, v16
    s_nop 1
    v_cndmask_b32 v199, 0, v18, vcc
    s_barrier
    s_lshr_b32 s9, s2, 4
    s_lshl_b32 s9, s9, 2
    s_add_u32 s9, s9, s3
    s_lshl_b32 s9, s9, 10
    s_add_u32 s9, s9, 16384000
    v_and_b32 v2, 15, v1
    v_lshl_add_u32 v10, v2, 6, s9
    s_lshl_b32 s9, s2, 2
    s_add_u32 s9, s9, s3
    s_lshl_b32 s9, s9, 12
    s_add_u32 s9, s9, 8388608
    s_lshl_b32 s10, s3, 12
    s_add_u32 m0, s10, 108544
    v_mov_b32 v13, 159744
    s_barrier
    s_waitcnt lgkmcnt(0)
    v_cvt_pk_bf16_f32 v48, v24, v25
    v_cvt_pk_bf16_f32 v49, v25, v26
    v_cvt_pk_bf16_f32 v50, v26, v27
    v_cvt_pk_bf16_f32 v51, v27, v28
    v_cvt_pk_bf16_f32 v52, v30, v30
    v_cvt_pk_bf16_f32 v53, v30, v31
    v_cvt_pk_bf16_f32 v54, v31, v32
    v_cvt_pk_bf16_f32 v55, v32, v32
    v_mov_b32 v80, 0
    v_mov_b32 v81, 0
    v_mov_b32 v82, 0
    v_cvt_pk_bf16_f32 v83, 0, v29
    v_cndmask_b32 v83, 0, v83, s[78:79]
    s_barrier
    v_cndmask_b32 v2, v34, v35, s[76:77]
    v_cvt_pk_bf16_f32 v56, v34, v34
    v_cvt_pk_bf16_f32 v59, v35, v35
    v_cvt_pk_bf16_f32 v57, v34, v2
    v_cvt_pk_bf16_f32 v58, v2, v35
    v_cndmask_b32 v2, v36, v37, s[76:77]
    v_cvt_pk_bf16_f32 v60, v36, v36
    v_cvt_pk_bf16_f32 v63, v37, v37
    v_cvt_pk_bf16_f32 v61, v36, v2
    v_cvt_pk_bf16_f32 v62, v2, v37
    s_barrier
    v_cndmask_b32 v2, v38, v39, s[78:79]
    v_cndmask_b32 v3, v38, v39, s[76:77]
    v_cndmask_b32 v15, v38, v39, s[12:13]
    v_cvt_pk_bf16_f32 v64, v2, v3
    v_cvt_pk_bf16_f32 v65, v3, v3
    v_cvt_pk_bf16_f32 v66, v3, v3
    v_cvt_pk_bf16_f32 v67, v3, v15
    v_cndmask_b32 v2, v40, v41, s[78:79]
    v_cndmask_b32 v3, v40, v41, s[76:77]
    v_cndmask_b32 v15, v40, v41, s[12:13]
    v_cvt_pk_bf16_f32 v68, v2, v3
    v_cvt_pk_bf16_f32 v69, v3, v3
    v_cvt_pk_bf16_f32 v70, v3, v3
    v_cvt_pk_bf16_f32 v71, v3, v15
    s_barrier
    v_cndmask_b32 v2, v42, v43, s[78:79]
    v_cndmask_b32 v3, v42, v43, s[76:77]
    v_cndmask_b32 v15, v42, v43, s[12:13]
    v_cvt_pk_bf16_f32 v72, v2, v3
    v_cvt_pk_bf16_f32 v73, v3, v3
    v_cvt_pk_bf16_f32 v74, v3, v3
    v_cvt_pk_bf16_f32 v75, v3, v15
    v_cndmask_b32 v2, v44, v45, s[78:79]
    v_cndmask_b32 v3, v44, v45, s[76:77]
    v_cndmask_b32 v15, v44, v45, s[12:13]
    v_cvt_pk_bf16_f32 v76, v2, v3
    v_cvt_pk_bf16_f32 v77, v3, v3
    v_cvt_pk_bf16_f32 v78, v3, v3
    v_cvt_pk_bf16_f32 v79, v3, v15
    s_barrier
    s_barrier
    s_barrier
    s_barrier
    s_setprio 3
    buffer_load_dwordx2 v[6:7], v10, s[60:63], 0 offen sc1
    s_setprio 0
    s_barrier
    ds_write_b128 v14, v[48:51] offset:64
    ds_write_b128 v14, v[52:55] offset:1088
    ds_write_b128 v14, v[56:59] offset:2112
    s_barrier
    s_waitcnt vmcnt(0)
    v_cmp_eq_u64 vcc, v[4:5], v[6:7]
    s_nop 0
    s_cmp_eq_u64 vcc, -1
    s_cselect_b32 s15, 0, 1
    s_setprio 3
    buffer_load_dwordx4 v9, s[60:63], s9 offen offset:0 sc1 lds
    buffer_load_dwordx4 v9, s[60:63], s9 offen offset:1024 sc1 lds
    s_setprio 0
    ds_write_b128 v14, v[60:63] offset:3136
    ds_write_b128 v14, v[64:67] offset:4160
    ds_write_b128 v14, v[68:71] offset:5184
    s_barrier
    s_setprio 3
    buffer_load_dwordx4 v9, s[60:63], s9 offen offset:2048 sc1 lds
    buffer_load_dwordx4 v9, s[60:63], s9 offen offset:3072 sc1 lds
    s_setprio 0
    ds_write_b128 v14, v[72:75] offset:6208
    ds_write_b128 v14, v[76:79] offset:7232
    s_mov_b64 exec, 0xf
    ds_write_b128 v14, v[80:83]
    s_mov_b64 exec, -1
    s_lshl_b32 s10, s3, 9
    s_add_u32 s10, s10, 106496
    v_lshl_add_u32 v2, v1, 3, s10
    ds_write_b64 v2, v[80:81]
    s_barrier
    s_setprio 3
    s_cmp_eq_u32 s15, 0
    s_cbranch_scc1 L_uok
    s_waitcnt vmcnt(0)
    v_cmp_eq_u64 vcc, v[4:5], v[6:7]
    s_nop 0
    s_cmp_eq_u64 vcc, -1
    s_cbranch_scc0 L_fl_17
L_fd_18:
    buffer_load_dwordx4 v9, s[60:63], s9 offen offset:0 sc1 lds
    buffer_load_dwordx4 v9, s[60:63], s9 offen offset:1024 sc1 lds
    buffer_load_dwordx4 v9, s[60:63], s9 offen offset:2048 sc1 lds
    buffer_load_dwordx4 v9, s[60:63], s9 offen offset:3072 sc1 lds
L_uok:
    s_setprio 1
    v_mov_b32 v2, 1
    s_waitcnt vmcnt(0)
    ds_write_b32 v12, v2
L_su:
    ds_read_b128 v[16:19], v13 offset:16
    s_waitcnt lgkmcnt(0)
    v_min3_u32 v2, v16, v17, v18
    v_min_u32 v2, v2, v19
    v_cmp_ne_u32 vcc, 0, v2
    s_cbranch_vccz L_su
    ds_read2_b32 v[56:57], v184 offset0:0 offset1:2
    ds_read2_b32 v[58:59], v184 offset0:4 offset1:6
    ds_read_b128 v[88:91], v192 offset:1024
    ds_read2_b32 v[60:61], v185 offset0:0 offset1:2
    ds_read2_b32 v[62:63], v185 offset0:4 offset1:6
    ds_read_b128 v[92:95], v192 offset:3072
    ds_read2_b32 v[64:65], v186 offset0:0 offset1:2
    ds_read2_b32 v[66:67], v186 offset0:4 offset1:6
    ds_read_b128 v[96:99], v192 offset:5120
    ds_read2_b32 v[68:69], v187 offset0:0 offset1:2
    ds_read2_b32 v[70:71], v187 offset0:4 offset1:6
    ds_read_b128 v[100:103], v192 offset:7168
    ds_read2_b32 v[72:73], v188 offset0:0 offset1:2
    ds_read2_b32 v[74:75], v188 offset0:4 offset1:6
    ds_read_b128 v[104:107], v192 offset:9216
    ds_read2_b32 v[76:77], v189 offset0:0 offset1:2
    ds_read2_b32 v[78:79], v189 offset0:4 offset1:6
    ds_read_b128 v[108:111], v192 offset:11264
    ds_read2_b32 v[80:81], v190 offset0:0 offset1:2
    ds_read2_b32 v[82:83], v190 offset0:4 offset1:6
    ds_read_b128 v[112:115], v192 offset:13312
    ds_read2_b32 v[84:85], v191 offset0:0 offset1:2
    ds_read2_b32 v[86:87], v191 offset0:4 offset1:6
    ds_read_b128 v[116:119], v192 offset:15360
    s_waitcnt lgkmcnt(15)
    v_mfma_f32_16x16x32_bf16 v[24:27], v[56:59], v[88:91], 0
    v_mfma_f32_16x16x32_bf16 v[24:27], v[196:199], v[88:91], v[24:27]
    v_mfma_f32_16x16x32_bf16 v[28:31], v[56:59], v[92:95], 0
    v_mfma_f32_16x16x32_bf16 v[28:31], v[60:63], v[88:91], v[28:31]
    v_mfma_f32_16x16x32_bf16 v[32:35], v[60:63], v[92:95], 0
    v_mfma_f32_16x16x32_bf16 v[28:31], v[196:199], v[92:95], v[28:31]
    v_mfma_f32_16x16x32_bf16 v[32:35], v[56:59], v[96:99], v[32:35]
    v_mfma_f32_16x16x32_bf16 v[36:39], v[60:63], v[96:99], 0
    v_mfma_f32_16x16x32_bf16 v[32:35], v[64:67], v[88:91], v[32:35]
    v_mfma_f32_16x16x32_bf16 v[36:39], v[64:67], v[92:95], v[36:39]
    v_mfma_f32_16x16x32_bf16 v[40:43], v[64:67], v[96:99], 0
    v_mfma_f32_16x16x32_bf16 v[32:35], v[196:199], v[96:99], v[32:35]
    s_waitcnt lgkmcnt(12)
    v_mfma_f32_16x16x32_bf16 v[36:39], v[56:59], v[100:103], v[36:39]
    ds_read2_b32 v[120:121], v184 offset0:32 offset1:34
    v_mfma_f32_16x16x32_bf16 v[40:43], v[60:63], v[100:103], v[40:43]
    ds_read2_b32 v[122:123], v184 offset0:36 offset1:38
    v_mfma_f32_16x16x32_bf16 v[44:47], v[64:67], v[100:103], 0
    ds_read_b128 v[152:155], v193 offset:1024
    v_mfma_f32_16x16x32_bf16 v[36:39], v[68:71], v[88:91], v[36:39]
    ds_read2_b32 v[124:125], v185 offset0:32 offset1:34
    v_mfma_f32_16x16x32_bf16 v[40:43], v[68:71], v[92:95], v[40:43]
    ds_read2_b32 v[126:127], v185 offset0:36 offset1:38
    v_mfma_f32_16x16x32_bf16 v[44:47], v[68:71], v[96:99], v[44:47]
    ds_read_b128 v[156:159], v193 offset:3072
    v_mfma_f32_16x16x32_bf16 v[48:51], v[68:71], v[100:103], 0
    ds_read2_b32 v[128:129], v186 offset0:32 offset1:34
    v_mfma_f32_16x16x32_bf16 v[36:39], v[196:199], v[100:103], v[36:39]
    ds_read2_b32 v[130:131], v186 offset0:36 offset1:38
    s_waitcnt lgkmcnt(15)
    v_mfma_f32_16x16x32_bf16 v[40:43], v[56:59], v[104:107], v[40:43]
    ds_read_b128 v[160:163], v193 offset:5120
    v_mfma_f32_16x16x32_bf16 v[44:47], v[60:63], v[104:107], v[44:47]
    ds_read2_b32 v[132:133], v187 offset0:32 offset1:34
    v_mfma_f32_16x16x32_bf16 v[48:51], v[64:67], v[104:107], v[48:51]
    ds_read2_b32 v[134:135], v187 offset0:36 offset1:38
    v_mfma_f32_16x16x32_bf16 v[52:55], v[68:71], v[104:107], 0
    ds_read_b128 v[164:167], v193 offset:7168
    v_mfma_f32_16x16x32_bf16 v[40:43], v[72:75], v[88:91], v[40:43]
    ds_read2_b32 v[136:137], v188 offset0:32 offset1:34
    v_mfma_f32_16x16x32_bf16 v[44:47], v[72:75], v[92:95], v[44:47]
    ds_read2_b32 v[138:139], v188 offset0:36 offset1:38
    v_mfma_f32_16x16x32_bf16 v[48:51], v[72:75], v[96:99], v[48:51]
    ds_read_b128 v[168:171], v193 offset:9216
    v_mfma_f32_16x16x32_bf16 v[52:55], v[72:75], v[100:103], v[52:55]
    ds_read2_b32 v[140:141], v189 offset0:32 offset1:34
    v_mfma_f32_16x16x32_bf16 v[40:43], v[196:199], v[104:107], v[40:43]
    ds_read2_b32 v[142:143], v189 offset0:36 offset1:38
    s_waitcnt lgkmcnt(15)
    v_mfma_f32_16x16x32_bf16 v[44:47], v[56:59], v[108:111], v[44:47]
    ds_read_b128 v[172:175], v193 offset:11264
    v_mfma_f32_16x16x32_bf16 v[48:51], v[60:63], v[108:111], v[48:51]
    ds_read2_b32 v[144:145], v190 offset0:32 offset1:34
    v_mfma_f32_16x16x32_bf16 v[52:55], v[64:67], v[108:111], v[52:55]
    ds_read2_b32 v[146:147], v190 offset0:36 offset1:38
    v_mfma_f32_16x16x32_bf16 v[44:47], v[76:79], v[88:91], v[44:47]
    ds_read_b128 v[176:179], v193 offset:13312
    v_mfma_f32_16x16x32_bf16 v[48:51], v[76:79], v[92:95], v[48:51]
    ds_read2_b32 v[148:149], v191 offset0:32 offset1:34
    v_mfma_f32_16x16x32_bf16 v[52:55], v[76:79], v[96:99], v[52:55]
    ds_read2_b32 v[150:151], v191 offset0:36 offset1:38
    v_mfma_f32_16x16x32_bf16 v[44:47], v[196:199], v[108:111], v[44:47]
    ds_read_b128 v[180:183], v193 offset:15360
    v_mfma_f32_16x16x32_bf16 v[48:51], v[56:59], v[112:115], v[48:51]
    v_mfma_f32_16x16x32_bf16 v[52:55], v[60:63], v[112:115], v[52:55]
    v_mfma_f32_16x16x32_bf16 v[48:51], v[80:83], v[88:91], v[48:51]
    v_mfma_f32_16x16x32_bf16 v[52:55], v[80:83], v[92:95], v[52:55]
    v_mfma_f32_16x16x32_bf16 v[48:51], v[196:199], v[112:115], v[48:51]
    v_mfma_f32_16x16x32_bf16 v[52:55], v[56:59], v[116:119], v[52:55]
    v_mfma_f32_16x16x32_bf16 v[52:55], v[84:87], v[88:91], v[52:55]
    v_mfma_f32_16x16x32_bf16 v[52:55], v[196:199], v[116:119], v[52:55]
    s_waitcnt lgkmcnt(15)
    v_mfma_f32_16x16x32_bf16 v[24:27], v[120:123], v[152:155], v[24:27]
    v_mfma_f32_16x16x32_bf16 v[28:31], v[120:123], v[156:159], v[28:31]
    v_mfma_f32_16x16x32_bf16 v[28:31], v[124:127], v[152:155], v[28:31]
    v_mfma_f32_16x16x32_bf16 v[32:35], v[124:127], v[156:159], v[32:35]
    v_mfma_f32_16x16x32_bf16 v[32:35], v[120:123], v[160:163], v[32:35]
    ds_read2_b32 v[56:57], v184 offset0:64 offset1:66
    v_mfma_f32_16x16x32_bf16 v[36:39], v[124:127], v[160:163], v[36:39]
    ds_read2_b32 v[58:59], v184 offset0:68 offset1:70
    v_mfma_f32_16x16x32_bf16 v[32:35], v[128:131], v[152:155], v[32:35]
    ds_read_b128 v[88:91], v194 offset:1024
    v_mfma_f32_16x16x32_bf16 v[36:39], v[128:131], v[156:159], v[36:39]
    ds_read2_b32 v[60:61], v185 offset0:64 offset1:66
    v_mfma_f32_16x16x32_bf16 v[40:43], v[128:131], v[160:163], v[40:43]
    ds_read2_b32 v[62:63], v185 offset0:68 offset1:70
    s_waitcnt lgkmcnt(15)
    v_mfma_f32_16x16x32_bf16 v[36:39], v[120:123], v[164:167], v[36:39]
    ds_read_b128 v[92:95], v194 offset:3072
    v_mfma_f32_16x16x32_bf16 v[40:43], v[124:127], v[164:167], v[40:43]
    ds_read2_b32 v[64:65], v186 offset0:64 offset1:66
    v_mfma_f32_16x16x32_bf16 v[44:47], v[128:131], v[164:167], v[44:47]
    ds_read2_b32 v[66:67], v186 offset0:68 offset1:70
    v_mfma_f32_16x16x32_bf16 v[36:39], v[132:135], v[152:155], v[36:39]
    ds_read_b128 v[96:99], v194 offset:5120
    v_mfma_f32_16x16x32_bf16 v[40:43], v[132:135], v[156:159], v[40:43]
    ds_read2_b32 v[68:69], v187 offset0:64 offset1:66
    v_mfma_f32_16x16x32_bf16 v[44:47], v[132:135], v[160:163], v[44:47]
    ds_read2_b32 v[70:71], v187 offset0:68 offset1:70
    v_mfma_f32_16x16x32_bf16 v[48:51], v[132:135], v[164:167], v[48:51]
    ds_read_b128 v[100:103], v194 offset:7168
    s_waitcnt lgkmcnt(15)
    v_mfma_f32_16x16x32_bf16 v[40:43], v[120:123], v[168:171], v[40:43]
    ds_read2_b32 v[72:73], v188 offset0:64 offset1:66
    v_mfma_f32_16x16x32_bf16 v[44:47], v[124:127], v[168:171], v[44:47]
    ds_read2_b32 v[74:75], v188 offset0:68 offset1:70
    v_mfma_f32_16x16x32_bf16 v[48:51], v[128:131], v[168:171], v[48:51]
    ds_read_b128 v[104:107], v194 offset:9216
    v_mfma_f32_16x16x32_bf16 v[52:55], v[132:135], v[168:171], v[52:55]
    ds_read2_b32 v[76:77], v189 offset0:64 offset1:66
    v_mfma_f32_16x16x32_bf16 v[40:43], v[136:139], v[152:155], v[40:43]
    ds_read2_b32 v[78:79], v189 offset0:68 offset1:70
    v_mfma_f32_16x16x32_bf16 v[44:47], v[136:139], v[156:159], v[44:47]
    ds_read_b128 v[108:111], v194 offset:11264
    v_mfma_f32_16x16x32_bf16 v[48:51], v[136:139], v[160:163], v[48:51]
    ds_read2_b32 v[80:81], v190 offset0:64 offset1:66
    v_mfma_f32_16x16x32_bf16 v[52:55], v[136:139], v[164:167], v[52:55]
    ds_read2_b32 v[82:83], v190 offset0:68 offset1:70
    v_mfma_f32_16x16x32_bf16 v[44:47], v[120:123], v[172:175], v[44:47]
    ds_read_b128 v[112:115], v194 offset:13312
    v_mfma_f32_16x16x32_bf16 v[48:51], v[124:127], v[172:175], v[48:51]
    ds_read2_b32 v[84:85], v191 offset0:64 offset1:66
    v_mfma_f32_16x16x32_bf16 v[52:55], v[128:131], v[172:175], v[52:55]
    ds_read2_b32 v[86:87], v191 offset0:68 offset1:70
    v_mfma_f32_16x16x32_bf16 v[44:47], v[140:143], v[152:155], v[44:47]
    ds_read_b128 v[116:119], v194 offset:15360
    v_mfma_f32_16x16x32_bf16 v[48:51], v[140:143], v[156:159], v[48:51]
    v_mfma_f32_16x16x32_bf16 v[52:55], v[140:143], v[160:163], v[52:55]
    v_mfma_f32_16x16x32_bf16 v[48:51], v[120:123], v[176:179], v[48:51]
    v_mfma_f32_16x16x32_bf16 v[52:55], v[124:127], v[176:179], v[52:55]
    v_mfma_f32_16x16x32_bf16 v[48:51], v[144:147], v[152:155], v[48:51]
    v_mfma_f32_16x16x32_bf16 v[52:55], v[144:147], v[156:159], v[52:55]
    s_waitcnt lgkmcnt(15)
    v_mfma_f32_16x16x32_bf16 v[52:55], v[120:123], v[180:183], v[52:55]
    v_mfma_f32_16x16x32_bf16 v[52:55], v[148:151], v[152:155], v[52:55]
    v_mfma_f32_16x16x32_bf16 v[24:27], v[56:59], v[88:91], v[24:27]
    v_mfma_f32_16x16x32_bf16 v[28:31], v[56:59], v[92:95], v[28:31]
    v_mfma_f32_16x16x32_bf16 v[28:31], v[60:63], v[88:91], v[28:31]
    v_mfma_f32_16x16x32_bf16 v[32:35], v[60:63], v[92:95], v[32:35]
    v_mfma_f32_16x16x32_bf16 v[32:35], v[56:59], v[96:99], v[32:35]
    ds_read2_b32 v[120:121], v184 offset0:96 offset1:98
    v_mfma_f32_16x16x32_bf16 v[36:39], v[60:63], v[96:99], v[36:39]
    ds_read2_b32 v[122:123], v184 offset0:100 offset1:102
    v_mfma_f32_16x16x32_bf16 v[32:35], v[64:67], v[88:91], v[32:35]
    ds_read_b128 v[152:155], v195 offset:1024
    v_mfma_f32_16x16x32_bf16 v[36:39], v[64:67], v[92:95], v[36:39]
    ds_read2_b32 v[124:125], v185 offset0:96 offset1:98
    v_mfma_f32_16x16x32_bf16 v[40:43], v[64:67], v[96:99], v[40:43]
    ds_read2_b32 v[126:127], v185 offset0:100 offset1:102
    s_waitcnt lgkmcnt(15)
    v_mfma_f32_16x16x32_bf16 v[36:39], v[56:59], v[100:103], v[36:39]
    ds_read_b128 v[156:159], v195 offset:3072
    v_mfma_f32_16x16x32_bf16 v[40:43], v[60:63], v[100:103], v[40:43]
    ds_read2_b32 v[128:129], v186 offset0:96 offset1:98
    v_mfma_f32_16x16x32_bf16 v[44:47], v[64:67], v[100:103], v[44:47]
    ds_read2_b32 v[130:131], v186 offset0:100 offset1:102
    v_mfma_f32_16x16x32_bf16 v[36:39], v[68:71], v[88:91], v[36:39]
    ds_read_b128 v[160:163], v195 offset:5120
    v_mfma_f32_16x16x32_bf16 v[40:43], v[68:71], v[92:95], v[40:43]
    ds_read2_b32 v[132:133], v187 offset0:96 offset1:98
    v_mfma_f32_16x16x32_bf16 v[44:47], v[68:71], v[96:99], v[44:47]
    ds_read2_b32 v[134:135], v187 offset0:100 offset1:102
    v_mfma_f32_16x16x32_bf16 v[48:51], v[68:71], v[100:103], v[48:51]
    ds_read_b128 v[164:167], v195 offset:7168
    s_waitcnt lgkmcnt(15)
    v_mfma_f32_16x16x32_bf16 v[40:43], v[56:59], v[104:107], v[40:43]
    ds_read2_b32 v[136:137], v188 offset0:96 offset1:98
    v_mfma_f32_16x16x32_bf16 v[44:47], v[60:63], v[104:107], v[44:47]
    ds_read2_b32 v[138:139], v188 offset0:100 offset1:102
    v_mfma_f32_16x16x32_bf16 v[48:51], v[64:67], v[104:107], v[48:51]
    ds_read_b128 v[168:171], v195 offset:9216
    v_mfma_f32_16x16x32_bf16 v[52:55], v[68:71], v[104:107], v[52:55]
    ds_read2_b32 v[140:141], v189 offset0:96 offset1:98
    v_mfma_f32_16x16x32_bf16 v[40:43], v[72:75], v[88:91], v[40:43]
    ds_read2_b32 v[142:143], v189 offset0:100 offset1:102
    v_mfma_f32_16x16x32_bf16 v[44:47], v[72:75], v[92:95], v[44:47]
    ds_read_b128 v[172:175], v195 offset:11264
    v_mfma_f32_16x16x32_bf16 v[48:51], v[72:75], v[96:99], v[48:51]
    ds_read2_b32 v[144:145], v190 offset0:96 offset1:98
    v_mfma_f32_16x16x32_bf16 v[52:55], v[72:75], v[100:103], v[52:55]
    ds_read2_b32 v[146:147], v190 offset0:100 offset1:102
    v_mfma_f32_16x16x32_bf16 v[44:47], v[56:59], v[108:111], v[44:47]
    ds_read_b128 v[176:179], v195 offset:13312
    v_mfma_f32_16x16x32_bf16 v[48:51], v[60:63], v[108:111], v[48:51]
    ds_read2_b32 v[148:149], v191 offset0:96 offset1:98
    v_mfma_f32_16x16x32_bf16 v[52:55], v[64:67], v[108:111], v[52:55]
    ds_read2_b32 v[150:151], v191 offset0:100 offset1:102
    v_mfma_f32_16x16x32_bf16 v[44:47], v[76:79], v[88:91], v[44:47]
    ds_read_b128 v[180:183], v195 offset:15360
    v_mfma_f32_16x16x32_bf16 v[48:51], v[76:79], v[92:95], v[48:51]
    v_mfma_f32_16x16x32_bf16 v[52:55], v[76:79], v[96:99], v[52:55]
    v_mfma_f32_16x16x32_bf16 v[48:51], v[56:59], v[112:115], v[48:51]
    v_mfma_f32_16x16x32_bf16 v[52:55], v[60:63], v[112:115], v[52:55]
    v_mfma_f32_16x16x32_bf16 v[48:51], v[80:83], v[88:91], v[48:51]
    v_mfma_f32_16x16x32_bf16 v[52:55], v[80:83], v[92:95], v[52:55]
    s_waitcnt lgkmcnt(15)
    v_mfma_f32_16x16x32_bf16 v[52:55], v[56:59], v[116:119], v[52:55]
    v_mfma_f32_16x16x32_bf16 v[52:55], v[84:87], v[88:91], v[52:55]
    v_mfma_f32_16x16x32_bf16 v[24:27], v[120:123], v[152:155], v[24:27]
    v_mfma_f32_16x16x32_bf16 v[28:31], v[120:123], v[156:159], v[28:31]
    v_mfma_f32_16x16x32_bf16 v[28:31], v[124:127], v[152:155], v[28:31]
    v_mfma_f32_16x16x32_bf16 v[32:35], v[124:127], v[156:159], v[32:35]
    v_mfma_f32_16x16x32_bf16 v[32:35], v[120:123], v[160:163], v[32:35]
    ds_read2_b32 v[56:57], v184 offset0:128 offset1:130
    v_mfma_f32_16x16x32_bf16 v[36:39], v[124:127], v[160:163], v[36:39]
    ds_read2_b32 v[58:59], v184 offset0:132 offset1:134
    v_mfma_f32_16x16x32_bf16 v[32:35], v[128:131], v[152:155], v[32:35]
    ds_read_b128 v[88:91], v192 offset:0
    v_mfma_f32_16x16x32_bf16 v[36:39], v[128:131], v[156:159], v[36:39]
    ds_read2_b32 v[60:61], v185 offset0:128 offset1:130
    v_mfma_f32_16x16x32_bf16 v[40:43], v[128:131], v[160:163], v[40:43]
    ds_read2_b32 v[62:63], v185 offset0:132 offset1:134
    s_waitcnt lgkmcnt(15)
    v_mfma_f32_16x16x32_bf16 v[36:39], v[120:123], v[164:167], v[36:39]
    ds_read_b128 v[92:95], v192 offset:2048
    v_mfma_f32_16x16x32_bf16 v[40:43], v[124:127], v[164:167], v[40:43]
    ds_read2_b32 v[64:65], v186 offset0:128 offset1:130
    v_mfma_f32_16x16x32_bf16 v[44:47], v[128:131], v[164:167], v[44:47]
    ds_read2_b32 v[66:67], v186 offset0:132 offset1:134
    v_mfma_f32_16x16x32_bf16 v[36:39], v[132:135], v[152:155], v[36:39]
    ds_read_b128 v[96:99], v192 offset:4096
    v_mfma_f32_16x16x32_bf16 v[40:43], v[132:135], v[156:159], v[40:43]
    ds_read2_b32 v[68:69], v187 offset0:128 offset1:130
    v_mfma_f32_16x16x32_bf16 v[44:47], v[132:135], v[160:163], v[44:47]
    ds_read2_b32 v[70:71], v187 offset0:132 offset1:134
    v_mfma_f32_16x16x32_bf16 v[48:51], v[132:135], v[164:167], v[48:51]
    ds_read_b128 v[100:103], v192 offset:6144
    s_waitcnt lgkmcnt(15)
    v_mfma_f32_16x16x32_bf16 v[40:43], v[120:123], v[168:171], v[40:43]
    ds_read2_b32 v[72:73], v188 offset0:128 offset1:130
    v_mfma_f32_16x16x32_bf16 v[44:47], v[124:127], v[168:171], v[44:47]
    ds_read2_b32 v[74:75], v188 offset0:132 offset1:134
    v_mfma_f32_16x16x32_bf16 v[48:51], v[128:131], v[168:171], v[48:51]
    ds_read_b128 v[104:107], v192 offset:8192
    v_mfma_f32_16x16x32_bf16 v[52:55], v[132:135], v[168:171], v[52:55]
    ds_read2_b32 v[76:77], v189 offset0:128 offset1:130
    v_mfma_f32_16x16x32_bf16 v[40:43], v[136:139], v[152:155], v[40:43]
    ds_read2_b32 v[78:79], v189 offset0:132 offset1:134
    v_mfma_f32_16x16x32_bf16 v[44:47], v[136:139], v[156:159], v[44:47]
    ds_read_b128 v[108:111], v192 offset:10240
    v_mfma_f32_16x16x32_bf16 v[48:51], v[136:139], v[160:163], v[48:51]
    ds_read2_b32 v[80:81], v190 offset0:128 offset1:130
    v_mfma_f32_16x16x32_bf16 v[52:55], v[136:139], v[164:167], v[52:55]
    ds_read2_b32 v[82:83], v190 offset0:132 offset1:134
    v_mfma_f32_16x16x32_bf16 v[44:47], v[120:123], v[172:175], v[44:47]
    ds_read_b128 v[112:115], v192 offset:12288
    v_mfma_f32_16x16x32_bf16 v[48:51], v[124:127], v[172:175], v[48:51]
    ds_read2_b32 v[84:85], v191 offset0:128 offset1:130
    v_mfma_f32_16x16x32_bf16 v[52:55], v[128:131], v[172:175], v[52:55]
    ds_read2_b32 v[86:87], v191 offset0:132 offset1:134
    v_mfma_f32_16x16x32_bf16 v[44:47], v[140:143], v[152:155], v[44:47]
    ds_read_b128 v[116:119], v192 offset:14336
    v_mfma_f32_16x16x32_bf16 v[48:51], v[140:143], v[156:159], v[48:51]
    v_mfma_f32_16x16x32_bf16 v[52:55], v[140:143], v[160:163], v[52:55]
    v_mfma_f32_16x16x32_bf16 v[48:51], v[120:123], v[176:179], v[48:51]
    v_mfma_f32_16x16x32_bf16 v[52:55], v[124:127], v[176:179], v[52:55]
    v_mfma_f32_16x16x32_bf16 v[48:51], v[144:147], v[152:155], v[48:51]
    v_mfma_f32_16x16x32_bf16 v[52:55], v[144:147], v[156:159], v[52:55]
    s_waitcnt lgkmcnt(15)
    v_mfma_f32_16x16x32_bf16 v[52:55], v[120:123], v[180:183], v[52:55]
    v_mfma_f32_16x16x32_bf16 v[52:55], v[148:151], v[152:155], v[52:55]
    v_mfma_f32_16x16x32_bf16 v[24:27], v[56:59], v[88:91], v[24:27]
    v_mfma_f32_16x16x32_bf16 v[28:31], v[56:59], v[92:95], v[28:31]
    v_mfma_f32_16x16x32_bf16 v[28:31], v[60:63], v[88:91], v[28:31]
    v_mfma_f32_16x16x32_bf16 v[32:35], v[60:63], v[92:95], v[32:35]
    v_mfma_f32_16x16x32_bf16 v[32:35], v[56:59], v[96:99], v[32:35]
    ds_read2_b32 v[120:121], v184 offset0:160 offset1:162
    v_mfma_f32_16x16x32_bf16 v[36:39], v[60:63], v[96:99], v[36:39]
    ds_read2_b32 v[122:123], v184 offset0:164 offset1:166
    v_mfma_f32_16x16x32_bf16 v[32:35], v[64:67], v[88:91], v[32:35]
    ds_read_b128 v[152:155], v193 offset:0
    v_mfma_f32_16x16x32_bf16 v[36:39], v[64:67], v[92:95], v[36:39]
    ds_read2_b32 v[124:125], v185 offset0:160 offset1:162
    v_mfma_f32_16x16x32_bf16 v[40:43], v[64:67], v[96:99], v[40:43]
    ds_read2_b32 v[126:127], v185 offset0:164 offset1:166
    s_waitcnt lgkmcnt(15)
    v_mfma_f32_16x16x32_bf16 v[36:39], v[56:59], v[100:103], v[36:39]
    ds_read_b128 v[156:159], v193 offset:2048
    v_mfma_f32_16x16x32_bf16 v[40:43], v[60:63], v[100:103], v[40:43]
    ds_read2_b32 v[128:129], v186 offset0:160 offset1:162
    v_mfma_f32_16x16x32_bf16 v[44:47], v[64:67], v[100:103], v[44:47]
    ds_read2_b32 v[130:131], v186 offset0:164 offset1:166
    v_mfma_f32_16x16x32_bf16 v[36:39], v[68:71], v[88:91], v[36:39]
    ds_read_b128 v[160:163], v193 offset:4096
    v_mfma_f32_16x16x32_bf16 v[40:43], v[68:71], v[92:95], v[40:43]
    ds_read2_b32 v[132:133], v187 offset0:160 offset1:162
    v_mfma_f32_16x16x32_bf16 v[44:47], v[68:71], v[96:99], v[44:47]
    ds_read2_b32 v[134:135], v187 offset0:164 offset1:166
    v_mfma_f32_16x16x32_bf16 v[48:51], v[68:71], v[100:103], v[48:51]
    ds_read_b128 v[164:167], v193 offset:6144
    s_waitcnt lgkmcnt(15)
    v_mfma_f32_16x16x32_bf16 v[40:43], v[56:59], v[104:107], v[40:43]
    ds_read2_b32 v[136:137], v188 offset0:160 offset1:162
    v_mfma_f32_16x16x32_bf16 v[44:47], v[60:63], v[104:107], v[44:47]
    ds_read2_b32 v[138:139], v188 offset0:164 offset1:166
    v_mfma_f32_16x16x32_bf16 v[48:51], v[64:67], v[104:107], v[48:51]
    ds_read_b128 v[168:171], v193 offset:8192
    v_mfma_f32_16x16x32_bf16 v[52:55], v[68:71], v[104:107], v[52:55]
    ds_read2_b32 v[140:141], v189 offset0:160 offset1:162
    v_mfma_f32_16x16x32_bf16 v[40:43], v[72:75], v[88:91], v[40:43]
    ds_read2_b32 v[142:143], v189 offset0:164 offset1:166
    v_mfma_f32_16x16x32_bf16 v[44:47], v[72:75], v[92:95], v[44:47]
    ds_read_b128 v[172:175], v193 offset:10240
    v_mfma_f32_16x16x32_bf16 v[48:51], v[72:75], v[96:99], v[48:51]
    ds_read2_b32 v[144:145], v190 offset0:160 offset1:162
    v_mfma_f32_16x16x32_bf16 v[52:55], v[72:75], v[100:103], v[52:55]
    ds_read2_b32 v[146:147], v190 offset0:164 offset1:166
    v_mfma_f32_16x16x32_bf16 v[44:47], v[56:59], v[108:111], v[44:47]
    ds_read_b128 v[176:179], v193 offset:12288
    v_mfma_f32_16x16x32_bf16 v[48:51], v[60:63], v[108:111], v[48:51]
    ds_read2_b32 v[148:149], v191 offset0:160 offset1:162
    v_mfma_f32_16x16x32_bf16 v[52:55], v[64:67], v[108:111], v[52:55]
    ds_read2_b32 v[150:151], v191 offset0:164 offset1:166
    v_mfma_f32_16x16x32_bf16 v[44:47], v[76:79], v[88:91], v[44:47]
    ds_read_b128 v[180:183], v193 offset:14336
    v_mfma_f32_16x16x32_bf16 v[48:51], v[76:79], v[92:95], v[48:51]
    v_mfma_f32_16x16x32_bf16 v[52:55], v[76:79], v[96:99], v[52:55]
    v_mfma_f32_16x16x32_bf16 v[48:51], v[56:59], v[112:115], v[48:51]
    v_mfma_f32_16x16x32_bf16 v[52:55], v[60:63], v[112:115], v[52:55]
    v_mfma_f32_16x16x32_bf16 v[48:51], v[80:83], v[88:91], v[48:51]
    v_mfma_f32_16x16x32_bf16 v[52:55], v[80:83], v[92:95], v[52:55]
    s_waitcnt lgkmcnt(15)
    v_mfma_f32_16x16x32_bf16 v[52:55], v[56:59], v[116:119], v[52:55]
    v_mfma_f32_16x16x32_bf16 v[52:55], v[84:87], v[88:91], v[52:55]
    v_mfma_f32_16x16x32_bf16 v[24:27], v[120:123], v[152:155], v[24:27]
    v_mfma_f32_16x16x32_bf16 v[28:31], v[120:123], v[156:159], v[28:31]
    v_mfma_f32_16x16x32_bf16 v[28:31], v[124:127], v[152:155], v[28:31]
    v_mfma_f32_16x16x32_bf16 v[32:35], v[124:127], v[156:159], v[32:35]
    v_mfma_f32_16x16x32_bf16 v[32:35], v[120:123], v[160:163], v[32:35]
    ds_read2_b32 v[56:57], v184 offset0:192 offset1:194
    v_mfma_f32_16x16x32_bf16 v[36:39], v[124:127], v[160:163], v[36:39]
    ds_read2_b32 v[58:59], v184 offset0:196 offset1:198
    v_mfma_f32_16x16x32_bf16 v[32:35], v[128:131], v[152:155], v[32:35]
    ds_read_b128 v[88:91], v194 offset:0
    v_mfma_f32_16x16x32_bf16 v[36:39], v[128:131], v[156:159], v[36:39]
    ds_read2_b32 v[60:61], v185 offset0:192 offset1:194
    v_mfma_f32_16x16x32_bf16 v[40:43], v[128:131], v[160:163], v[40:43]
    ds_read2_b32 v[62:63], v185 offset0:196 offset1:198
    s_waitcnt lgkmcnt(15)
    v_mfma_f32_16x16x32_bf16 v[36:39], v[120:123], v[164:167], v[36:39]
    ds_read_b128 v[92:95], v194 offset:2048
    v_mfma_f32_16x16x32_bf16 v[40:43], v[124:127], v[164:167], v[40:43]
    ds_read2_b32 v[64:65], v186 offset0:192 offset1:194
    v_mfma_f32_16x16x32_bf16 v[44:47], v[128:131], v[164:167], v[44:47]
    ds_read2_b32 v[66:67], v186 offset0:196 offset1:198
    v_mfma_f32_16x16x32_bf16 v[36:39], v[132:135], v[152:155], v[36:39]
    ds_read_b128 v[96:99], v194 offset:4096
    v_mfma_f32_16x16x32_bf16 v[40:43], v[132:135], v[156:159], v[40:43]
    ds_read2_b32 v[68:69], v187 offset0:192 offset1:194
    v_mfma_f32_16x16x32_bf16 v[44:47], v[132:135], v[160:163], v[44:47]
    ds_read2_b32 v[70:71], v187 offset0:196 offset1:198
    v_mfma_f32_16x16x32_bf16 v[48:51], v[132:135], v[164:167], v[48:51]
    ds_read_b128 v[100:103], v194 offset:6144
    s_waitcnt lgkmcnt(15)
    v_mfma_f32_16x16x32_bf16 v[40:43], v[120:123], v[168:171], v[40:43]
    ds_read2_b32 v[72:73], v188 offset0:192 offset1:194
    v_mfma_f32_16x16x32_bf16 v[44:47], v[124:127], v[168:171], v[44:47]
    ds_read2_b32 v[74:75], v188 offset0:196 offset1:198
    v_mfma_f32_16x16x32_bf16 v[48:51], v[128:131], v[168:171], v[48:51]
    ds_read_b128 v[104:107], v194 offset:8192
    v_mfma_f32_16x16x32_bf16 v[52:55], v[132:135], v[168:171], v[52:55]
    ds_read2_b32 v[76:77], v189 offset0:192 offset1:194
    v_mfma_f32_16x16x32_bf16 v[40:43], v[136:139], v[152:155], v[40:43]
    ds_read2_b32 v[78:79], v189 offset0:196 offset1:198
    v_mfma_f32_16x16x32_bf16 v[44:47], v[136:139], v[156:159], v[44:47]
    ds_read_b128 v[108:111], v194 offset:10240
    v_mfma_f32_16x16x32_bf16 v[48:51], v[136:139], v[160:163], v[48:51]
    ds_read2_b32 v[80:81], v190 offset0:192 offset1:194
    v_mfma_f32_16x16x32_bf16 v[52:55], v[136:139], v[164:167], v[52:55]
    ds_read2_b32 v[82:83], v190 offset0:196 offset1:198
    v_mfma_f32_16x16x32_bf16 v[44:47], v[120:123], v[172:175], v[44:47]
    ds_read_b128 v[112:115], v194 offset:12288
    v_mfma_f32_16x16x32_bf16 v[48:51], v[124:127], v[172:175], v[48:51]
    ds_read2_b32 v[84:85], v191 offset0:192 offset1:194
    v_mfma_f32_16x16x32_bf16 v[52:55], v[128:131], v[172:175], v[52:55]
    ds_read2_b32 v[86:87], v191 offset0:196 offset1:198
    v_mfma_f32_16x16x32_bf16 v[44:47], v[140:143], v[152:155], v[44:47]
    ds_read_b128 v[116:119], v194 offset:14336
    v_mfma_f32_16x16x32_bf16 v[48:51], v[140:143], v[156:159], v[48:51]
    v_mfma_f32_16x16x32_bf16 v[52:55], v[140:143], v[160:163], v[52:55]
    v_mfma_f32_16x16x32_bf16 v[48:51], v[120:123], v[176:179], v[48:51]
    v_mfma_f32_16x16x32_bf16 v[52:55], v[124:127], v[176:179], v[52:55]
    v_mfma_f32_16x16x32_bf16 v[48:51], v[144:147], v[152:155], v[48:51]
    v_mfma_f32_16x16x32_bf16 v[52:55], v[144:147], v[156:159], v[52:55]
    s_waitcnt lgkmcnt(15)
    v_mfma_f32_16x16x32_bf16 v[52:55], v[120:123], v[180:183], v[52:55]
    v_mfma_f32_16x16x32_bf16 v[52:55], v[148:151], v[152:155], v[52:55]
    v_mfma_f32_16x16x32_bf16 v[24:27], v[56:59], v[88:91], v[24:27]
    v_mfma_f32_16x16x32_bf16 v[28:31], v[56:59], v[92:95], v[28:31]
    v_mfma_f32_16x16x32_bf16 v[28:31], v[60:63], v[88:91], v[28:31]
    v_mfma_f32_16x16x32_bf16 v[32:35], v[60:63], v[92:95], v[32:35]
    v_mfma_f32_16x16x32_bf16 v[32:35], v[56:59], v[96:99], v[32:35]
    ds_read2_b32 v[120:121], v184 offset0:224 offset1:226
    v_mfma_f32_16x16x32_bf16 v[36:39], v[60:63], v[96:99], v[36:39]
    ds_read2_b32 v[122:123], v184 offset0:228 offset1:230
    v_mfma_f32_16x16x32_bf16 v[32:35], v[64:67], v[88:91], v[32:35]
    ds_read_b128 v[152:155], v195 offset:0
    v_mfma_f32_16x16x32_bf16 v[36:39], v[64:67], v[92:95], v[36:39]
    ds_read2_b32 v[124:125], v185 offset0:224 offset1:226
    v_mfma_f32_16x16x32_bf16 v[40:43], v[64:67], v[96:99], v[40:43]
    ds_read2_b32 v[126:127], v185 offset0:228 offset1:230
    s_waitcnt lgkmcnt(15)
    v_mfma_f32_16x16x32_bf16 v[36:39], v[56:59], v[100:103], v[36:39]
    ds_read_b128 v[156:159], v195 offset:2048
    v_mfma_f32_16x16x32_bf16 v[40:43], v[60:63], v[100:103], v[40:43]
    ds_read2_b32 v[128:129], v186 offset0:224 offset1:226
    v_mfma_f32_16x16x32_bf16 v[44:47], v[64:67], v[100:103], v[44:47]
    ds_read2_b32 v[130:131], v186 offset0:228 offset1:230
    v_mfma_f32_16x16x32_bf16 v[36:39], v[68:71], v[88:91], v[36:39]
    ds_read_b128 v[160:163], v195 offset:4096
    v_mfma_f32_16x16x32_bf16 v[40:43], v[68:71], v[92:95], v[40:43]
    ds_read2_b32 v[132:133], v187 offset0:224 offset1:226
    v_mfma_f32_16x16x32_bf16 v[44:47], v[68:71], v[96:99], v[44:47]
    ds_read2_b32 v[134:135], v187 offset0:228 offset1:230
    v_mfma_f32_16x16x32_bf16 v[48:51], v[68:71], v[100:103], v[48:51]
    ds_read_b128 v[164:167], v195 offset:6144
    s_waitcnt lgkmcnt(15)
    v_mfma_f32_16x16x32_bf16 v[40:43], v[56:59], v[104:107], v[40:43]
    ds_read2_b32 v[136:137], v188 offset0:224 offset1:226
    v_mfma_f32_16x16x32_bf16 v[44:47], v[60:63], v[104:107], v[44:47]
    ds_read2_b32 v[138:139], v188 offset0:228 offset1:230
    v_mfma_f32_16x16x32_bf16 v[48:51], v[64:67], v[104:107], v[48:51]
    ds_read_b128 v[168:171], v195 offset:8192
    v_mfma_f32_16x16x32_bf16 v[52:55], v[68:71], v[104:107], v[52:55]
    ds_read2_b32 v[140:141], v189 offset0:224 offset1:226
    v_mfma_f32_16x16x32_bf16 v[40:43], v[72:75], v[88:91], v[40:43]
    ds_read2_b32 v[142:143], v189 offset0:228 offset1:230
    v_mfma_f32_16x16x32_bf16 v[44:47], v[72:75], v[92:95], v[44:47]
    ds_read_b128 v[172:175], v195 offset:10240
    v_mfma_f32_16x16x32_bf16 v[48:51], v[72:75], v[96:99], v[48:51]
    ds_read2_b32 v[144:145], v190 offset0:224 offset1:226
    v_mfma_f32_16x16x32_bf16 v[52:55], v[72:75], v[100:103], v[52:55]
    ds_read2_b32 v[146:147], v190 offset0:228 offset1:230
    v_mfma_f32_16x16x32_bf16 v[44:47], v[56:59], v[108:111], v[44:47]
    ds_read_b128 v[176:179], v195 offset:12288
    v_mfma_f32_16x16x32_bf16 v[48:51], v[60:63], v[108:111], v[48:51]
    ds_read2_b32 v[148:149], v191 offset0:224 offset1:226
    v_mfma_f32_16x16x32_bf16 v[52:55], v[64:67], v[108:111], v[52:55]
    ds_read2_b32 v[150:151], v191 offset0:228 offset1:230
    v_mfma_f32_16x16x32_bf16 v[44:47], v[76:79], v[88:91], v[44:47]
    ds_read_b128 v[180:183], v195 offset:14336
    v_mfma_f32_16x16x32_bf16 v[48:51], v[76:79], v[92:95], v[48:51]
    v_mfma_f32_16x16x32_bf16 v[52:55], v[76:79], v[96:99], v[52:55]
    v_mfma_f32_16x16x32_bf16 v[48:51], v[56:59], v[112:115], v[48:51]
    v_mfma_f32_16x16x32_bf16 v[52:55], v[60:63], v[112:115], v[52:55]
    v_mfma_f32_16x16x32_bf16 v[48:51], v[80:83], v[88:91], v[48:51]
    v_mfma_f32_16x16x32_bf16 v[52:55], v[80:83], v[92:95], v[52:55]
    s_waitcnt lgkmcnt(15)
    v_mfma_f32_16x16x32_bf16 v[52:55], v[56:59], v[116:119], v[52:55]
    v_mfma_f32_16x16x32_bf16 v[52:55], v[84:87], v[88:91], v[52:55]
    v_mfma_f32_16x16x32_bf16 v[24:27], v[120:123], v[152:155], v[24:27]
    v_mfma_f32_16x16x32_bf16 v[28:31], v[120:123], v[156:159], v[28:31]
    v_mfma_f32_16x16x32_bf16 v[28:31], v[124:127], v[152:155], v[28:31]
    v_mfma_f32_16x16x32_bf16 v[32:35], v[124:127], v[156:159], v[32:35]
    v_mfma_f32_16x16x32_bf16 v[32:35], v[120:123], v[160:163], v[32:35]
    v_mfma_f32_16x16x32_bf16 v[36:39], v[124:127], v[160:163], v[36:39]
    v_mfma_f32_16x16x32_bf16 v[32:35], v[128:131], v[152:155], v[32:35]
    v_mfma_f32_16x16x32_bf16 v[36:39], v[128:131], v[156:159], v[36:39]
    v_mfma_f32_16x16x32_bf16 v[40:43], v[128:131], v[160:163], v[40:43]
    s_waitcnt lgkmcnt(12)
    v_mfma_f32_16x16x32_bf16 v[36:39], v[120:123], v[164:167], v[36:39]
    v_mfma_f32_16x16x32_bf16 v[40:43], v[124:127], v[164:167], v[40:43]
    v_mfma_f32_16x16x32_bf16 v[44:47], v[128:131], v[164:167], v[44:47]
    v_mfma_f32_16x16x32_bf16 v[36:39], v[132:135], v[152:155], v[36:39]
    v_mfma_f32_16x16x32_bf16 v[40:43], v[132:135], v[156:159], v[40:43]
    v_mfma_f32_16x16x32_bf16 v[44:47], v[132:135], v[160:163], v[44:47]
    v_mfma_f32_16x16x32_bf16 v[48:51], v[132:135], v[164:167], v[48:51]
    s_waitcnt lgkmcnt(9)
    v_mfma_f32_16x16x32_bf16 v[40:43], v[120:123], v[168:171], v[40:43]
    v_mfma_f32_16x16x32_bf16 v[44:47], v[124:127], v[168:171], v[44:47]
    v_mfma_f32_16x16x32_bf16 v[48:51], v[128:131], v[168:171], v[48:51]
    v_mfma_f32_16x16x32_bf16 v[52:55], v[132:135], v[168:171], v[52:55]
    v_mfma_f32_16x16x32_bf16 v[40:43], v[136:139], v[152:155], v[40:43]
    v_mfma_f32_16x16x32_bf16 v[44:47], v[136:139], v[156:159], v[44:47]
    v_mfma_f32_16x16x32_bf16 v[48:51], v[136:139], v[160:163], v[48:51]
    v_mfma_f32_16x16x32_bf16 v[52:55], v[136:139], v[164:167], v[52:55]
    s_waitcnt lgkmcnt(6)
    v_mfma_f32_16x16x32_bf16 v[44:47], v[120:123], v[172:175], v[44:47]
    v_mfma_f32_16x16x32_bf16 v[48:51], v[124:127], v[172:175], v[48:51]
    v_mfma_f32_16x16x32_bf16 v[52:55], v[128:131], v[172:175], v[52:55]
    v_mfma_f32_16x16x32_bf16 v[44:47], v[140:143], v[152:155], v[44:47]
    v_mfma_f32_16x16x32_bf16 v[48:51], v[140:143], v[156:159], v[48:51]
    v_mfma_f32_16x16x32_bf16 v[52:55], v[140:143], v[160:163], v[52:55]
    s_waitcnt lgkmcnt(3)
    v_mfma_f32_16x16x32_bf16 v[48:51], v[120:123], v[176:179], v[48:51]
    v_mfma_f32_16x16x32_bf16 v[52:55], v[124:127], v[176:179], v[52:55]
    v_mfma_f32_16x16x32_bf16 v[48:51], v[144:147], v[152:155], v[48:51]
    v_mfma_f32_16x16x32_bf16 v[52:55], v[144:147], v[156:159], v[52:55]
    s_waitcnt lgkmcnt(0)
    v_mfma_f32_16x16x32_bf16 v[52:55], v[120:123], v[180:183], v[52:55]
    v_mfma_f32_16x16x32_bf16 v[52:55], v[148:151], v[152:155], v[52:55]
    s_setprio 3
    v_and_b32 v2, 15, v1
    v_lshlrev_b32 v2, 5, v2
    v_bfe_u32 v3, v1, 4, 1
    v_lshl_add_u32 v2, v3, 9, v2
    v_lshrrev_b32 v3, 5, v1
    v_lshl_add_u32 v2, v3, 4, v2
    s_lshl_b32 s9, s81, 12
    s_add_u32 s9, s9, 12582912
    s_lshl_b32 s10, s81, 6
    s_add_u32 s10, s10, 16449536
    v_cvt_pk_bf16_f32 v56, v24, v25
    v_cvt_pk_bf16_f32 v57, v26, v27
    v_cvt_pk_bf16_f32 v58, v28, v29
    v_cvt_pk_bf16_f32 v59, v30, v31
    v_cvt_pk_bf16_f32 v60, v32, v33
    v_cvt_pk_bf16_f32 v61, v34, v35
    v_cvt_pk_bf16_f32 v62, v36, v37
    v_cvt_pk_bf16_f32 v63, v38, v39
    v_cvt_pk_bf16_f32 v64, v40, v41
    v_cvt_pk_bf16_f32 v65, v42, v43
    v_cvt_pk_bf16_f32 v66, v44, v45
    v_cvt_pk_bf16_f32 v67, v46, v47
    v_cvt_pk_bf16_f32 v68, v48, v49
    v_cvt_pk_bf16_f32 v69, v50, v51
    v_cvt_pk_bf16_f32 v70, v52, v53
    v_cvt_pk_bf16_f32 v71, v54, v55
    v_permlane16_swap_b32 v56, v58
    v_permlane16_swap_b32 v57, v59
    buffer_store_dwordx4 v[56:59], v2, s[60:63], s9 offen offset:0 sc1
    v_permlane16_swap_b32 v60, v62
    v_permlane16_swap_b32 v61, v63
    buffer_store_dwordx4 v[60:63], v2, s[60:63], s9 offen offset:1024 sc1
    v_permlane16_swap_b32 v64, v66
    v_permlane16_swap_b32 v65, v67
    buffer_store_dwordx4 v[64:67], v2, s[60:63], s9 offen offset:2048 sc1
    s_nop 0
    v_permlane16_swap_b32 v68, v70
    v_permlane16_swap_b32 v69, v71
    buffer_store_dwordx4 v[68:71], v2, s[60:63], s9 offen offset:3072 sc1
    s_waitcnt vmcnt(0)
    s_mov_b64 exec, 1
    buffer_store_dwordx2 v[4:5], v8, s[60:63], s10 offen sc1
    s_mov_b64 exec, -1
    s_endpgm
L_p:
    v_mov_b32 v8, 0
    s_sub_u32 s79, s2, 224
    s_lshl_b32 s10, s79, 2
    s_add_u32 s10, s10, s3
    s_cmp_lg_u32 s10, 0
    s_cbranch_scc1 L_nonn
    s_memrealtime s[98:99]
    s_waitcnt lgkmcnt(0)
    s_or_b32 s12, s98, 1
    s_or_b32 s13, s99, 0x80000000
    v_mov_b32 v4, s12
    v_mov_b32 v5, s13
    s_mov_b64 exec, 1
    buffer_store_dwordx2 v[4:5], v8, s[72:75], 0 offen sc1
    s_mov_b64 exec, -1
L_nonn:
    s_barrier
    s_add_u32 s4, s2, 1
    s_and_b32 s4, s4, 3
    s_lshl_b32 s4, s4, 1
    s_bfe_u32 s5, s2, 0x10002
    s_add_u32 s4, s4, s5
    s_lshl_b32 s4, s4, 2
    s_bfe_u32 s5, s2, 0x20003
    s_add_u32 s4, s4, s5
    s_lshr_b32 s5, s2, 5
    s_mul_i32 s6, s3, 14
    s_cmp_eq_u32 s3, 3
    s_cselect_b32 s6, 41, s6
    v_mov_b32 v8, 0
    v_lshlrev_b32 v9, 4, v1
    s_cmp_ge_u32 s3, 2
    s_cselect_b32 s10, 12, 13
    v_and_b32 v2, 31, v1
    v_min_u32 v2, s10, v2
    v_add_u32 v2, s6, v2
    s_mul_i32 s10, s5, 5
    s_lshr_b32 s10, s10, 2
    v_lshrrev_b32 v3, 5, v1
    v_add_u32 v3, s10, v3
    v_lshlrev_b32 v3, 12, v3
    v_lshl_add_u32 v10, v2, 6, v3
    v_add_u32 v10, 16318464, v10
    s_mov_b32 s68, s40
    s_mov_b32 s69, s41
    s_mov_b32 s70, 0x500
    s_mov_b32 s71, 0x00020000
    s_and_b32 s76, s79, 3
    s_lshl_b32 s76, s76, 3
    s_lshr_b32 s77, s79, 2
    s_add_u32 s76, s76, s77
    s_lshl_b32 s76, s76, 6
    s_lshl_b32 s77, s3, 4
    s_add_u32 s76, s76, s77
    s_mul_i32 s78, s76, 1280
    v_mov_b32 v2, 0
    v_mul_u32_u24 v3, 80, v2
    v_sub_u32 v3, v1, v3
    v_add_u32 v3, 0, v3
    v_lshlrev_b32 v30, 1, v2
    v_xor_b32 v3, v3, v30
    v_mul_u32_u24 v2, 1280, v2
    v_lshl_add_u32 v14, v3, 4, v2
    v_xor_b32 v3, 8, v3
    v_lshl_add_u32 v19, v3, 4, v2
    v_cmp_le_u32 vcc, 16, v1
    v_mov_b32 v2, 0
    v_mov_b32 v3, 1
    v_cndmask_b32 v2, v2, v3, vcc
    v_mul_u32_u24 v3, 80, v2
    v_sub_u32 v3, v1, v3
    v_add_u32 v3, 64, v3
    v_lshlrev_b32 v30, 1, v2
    v_xor_b32 v3, v3, v30
    v_mul_u32_u24 v2, 1280, v2
    v_lshl_add_u32 v15, v3, 4, v2
    v_xor_b32 v3, 8, v3
    v_lshl_add_u32 v20, v3, 4, v2
    v_cmp_le_u32 vcc, 32, v1
    v_mov_b32 v2, 1
    v_mov_b32 v3, 2
    v_cndmask_b32 v2, v2, v3, vcc
    v_mul_u32_u24 v3, 80, v2
    v_sub_u32 v3, v1, v3
    v_add_u32 v3, 128, v3
    v_lshlrev_b32 v30, 1, v2
    v_xor_b32 v3, v3, v30
    v_mul_u32_u24 v2, 1280, v2
    v_lshl_add_u32 v16, v3, 4, v2
    v_xor_b32 v3, 8, v3
    v_lshl_add_u32 v21, v3, 4, v2
    v_cmp_le_u32 vcc, 48, v1
    v_mov_b32 v2, 2
    v_mov_b32 v3, 3
    v_cndmask_b32 v2, v2, v3, vcc
    v_mul_u32_u24 v3, 80, v2
    v_sub_u32 v3, v1, v3
    v_add_u32 v3, 192, v3
    v_lshlrev_b32 v30, 1, v2
    v_xor_b32 v3, v3, v30
    v_mul_u32_u24 v2, 1280, v2
    v_lshl_add_u32 v17, v3, 4, v2
    v_xor_b32 v3, 8, v3
    v_lshl_add_u32 v22, v3, 4, v2
    v_mov_b32 v2, 3
    v_mul_u32_u24 v3, 80, v2
    v_sub_u32 v3, v1, v3
    v_add_u32 v3, 256, v3
    v_lshlrev_b32 v30, 1, v2
    v_xor_b32 v3, v3, v30
    v_mul_u32_u24 v2, 1280, v2
    v_lshl_add_u32 v18, v3, 4, v2
    v_xor_b32 v3, 8, v3
    v_lshl_add_u32 v23, v3, 4, v2
    s_mul_i32 s77, s3, 20480
    v_and_b32 v2, 15, v1
    v_mul_u32_u24 v30, 1280, v2
    v_add_u32 v30, s77, v30
    v_and_b32 v2, 3, v1
    v_bfe_u32 v3, v1, 3, 1
    v_lshl_add_u32 v2, v3, 2, v2
    v_lshlrev_b32 v2, 1, v2
    v_lshrrev_b32 v3, 4, v1
    v_xor_b32 v2, v2, v3
    v_lshlrev_b32 v2, 4, v2
    v_xor_b32 v3, 0, v2
    v_add_u32 v26, v3, v30
    v_xor_b32 v3, 64, v2
    v_add_u32 v27, v3, v30
    v_xor_b32 v3, 128, v2
    v_add_u32 v28, v3, v30
    v_xor_b32 v3, 192, v2
    v_add_u32 v29, v3, v30
    s_waitcnt vmcnt(0)
    s_add_u32 m0, s77, 0
    s_nop 0
    buffer_load_dwordx4 v14, s[48:51], s78 offen lds
    s_add_u32 m0, s77, 1024
    s_nop 0
    buffer_load_dwordx4 v15, s[48:51], s78 offen lds
    s_add_u32 m0, s77, 2048
    s_nop 0
    buffer_load_dwordx4 v16, s[48:51], s78 offen lds
    s_add_u32 m0, s77, 3072
    s_nop 0
    buffer_load_dwordx4 v17, s[48:51], s78 offen lds
    s_add_u32 m0, s77, 4096
    s_nop 0
    buffer_load_dwordx4 v18, s[48:51], s78 offen lds
    s_add_u32 s78, s78, 5120
    s_add_u32 m0, s77, 5120
    s_nop 0
    buffer_load_dwordx4 v14, s[48:51], s78 offen lds
    s_add_u32 m0, s77, 6144
    s_nop 0
    buffer_load_dwordx4 v15, s[48:51], s78 offen lds
    s_add_u32 m0, s77, 7168
    s_nop 0
    buffer_load_dwordx4 v16, s[48:51], s78 offen lds
    s_add_u32 m0, s77, 8192
    s_nop 0
    buffer_load_dwordx4 v17, s[48:51], s78 offen lds
    s_add_u32 m0, s77, 9216
    s_nop 0
    buffer_load_dwordx4 v18, s[48:51], s78 offen lds
    s_add_u32 s78, s78, 5120
    s_add_u32 m0, s77, 10240
    s_nop 0
    buffer_load_dwordx4 v19, s[48:51], s78 offen lds
    s_add_u32 m0, s77, 11264
    s_nop 0
    buffer_load_dwordx4 v20, s[48:51], s78 offen lds
    s_add_u32 m0, s77, 12288
    s_nop 0
    buffer_load_dwordx4 v21, s[48:51], s78 offen lds
    s_add_u32 m0, s77, 13312
    s_nop 0
    buffer_load_dwordx4 v22, s[48:51], s78 offen lds
    s_add_u32 m0, s77, 14336
    s_nop 0
    buffer_load_dwordx4 v23, s[48:51], s78 offen lds
    s_add_u32 s78, s78, 5120
    s_add_u32 m0, s77, 15360
    s_nop 0
    buffer_load_dwordx4 v19, s[48:51], s78 offen lds
    s_add_u32 m0, s77, 16384
    s_nop 0
    buffer_load_dwordx4 v20, s[48:51], s78 offen lds
    s_add_u32 m0, s77, 17408
    s_nop 0
    buffer_load_dwordx4 v21, s[48:51], s78 offen lds
    s_add_u32 m0, s77, 18432
    s_nop 0
    buffer_load_dwordx4 v22, s[48:51], s78 offen lds
    s_add_u32 m0, s77, 19456
    s_nop 0
    buffer_load_dwordx4 v23, s[48:51], s78 offen lds
    v_lshrrev_b32 v2, 4, v1
    v_lshlrev_b32 v2, 4, v2
    buffer_load_dwordx4 v[32:35], v2, s[68:71], 0 offen offset:0
    buffer_load_dwordx4 v[36:39], v2, s[68:71], 0 offen offset:64
    buffer_load_dwordx4 v[40:43], v2, s[68:71], 0 offen offset:128
    buffer_load_dwordx4 v[44:47], v2, s[68:71], 0 offen offset:192
    buffer_load_dwordx4 v[48:51], v2, s[68:71], 0 offen offset:256
    buffer_load_dwordx4 v[52:55], v2, s[68:71], 0 offen offset:320
    buffer_load_dwordx4 v[56:59], v2, s[68:71], 0 offen offset:384
    buffer_load_dwordx4 v[60:63], v2, s[68:71], 0 offen offset:448
    buffer_load_dwordx4 v[64:67], v2, s[68:71], 0 offen offset:512
    buffer_load_dwordx4 v[68:71], v2, s[68:71], 0 offen offset:576
    buffer_load_dwordx4 v[72:75], v2, s[68:71], 0 offen offset:640
    buffer_load_dwordx4 v[76:79], v2, s[68:71], 0 offen offset:704
    buffer_load_dwordx4 v[80:83], v2, s[68:71], 0 offen offset:768
    buffer_load_dwordx4 v[84:87], v2, s[68:71], 0 offen offset:832
    buffer_load_dwordx4 v[88:91], v2, s[68:71], 0 offen offset:896
    buffer_load_dwordx4 v[92:95], v2, s[68:71], 0 offen offset:960
    buffer_load_dwordx4 v[96:99], v2, s[68:71], 0 offen offset:1024
    buffer_load_dwordx4 v[100:103], v2, s[68:71], 0 offen offset:1088
    buffer_load_dwordx4 v[104:107], v2, s[68:71], 0 offen offset:1152
    buffer_load_dwordx4 v[108:111], v2, s[68:71], 0 offen offset:1216
    buffer_load_dwordx2 v[4:5], v8, s[72:75], 0 offen sc1
    s_waitcnt vmcnt(21)
    ds_read_b128 v[112:115], v26 offset:0
    ds_read_b128 v[116:119], v27 offset:0
    ds_read_b128 v[120:123], v28 offset:0
    ds_read_b128 v[124:127], v29 offset:0
    ds_read_b128 v[128:131], v26 offset:256
    ds_read_b128 v[132:135], v27 offset:256
    ds_read_b128 v[136:139], v28 offset:256
    ds_read_b128 v[140:143], v29 offset:256
    ds_read_b128 v[144:147], v26 offset:512
    ds_read_b128 v[148:151], v27 offset:512
    ds_read_b128 v[152:155], v28 offset:512
    ds_read_b128 v[156:159], v29 offset:512
    ds_read_b128 v[160:163], v26 offset:768
    ds_read_b128 v[164:167], v27 offset:768
    ds_read_b128 v[168:171], v28 offset:768
    ds_read_b128 v[172:175], v29 offset:768
    ds_read_b128 v[176:179], v26 offset:1024
    ds_read_b128 v[180:183], v27 offset:1024
    ds_read_b128 v[184:187], v28 offset:1024
    ds_read_b128 v[188:191], v29 offset:1024
    s_waitcnt vmcnt(1)
    s_waitcnt lgkmcnt(15)
    v_mfma_f32_16x16x32_bf16 v[224:227], v[32:35], v[112:115], 0
    v_mfma_f32_16x16x32_bf16 v[224:227], v[36:39], v[116:119], v[224:227]
    v_mfma_f32_16x16x32_bf16 v[224:227], v[40:43], v[120:123], v[224:227]
    v_mfma_f32_16x16x32_bf16 v[224:227], v[44:47], v[124:127], v[224:227]
    v_mfma_f32_16x16x32_bf16 v[224:227], v[48:51], v[128:131], v[224:227]
    s_waitcnt lgkmcnt(14)
    v_mfma_f32_16x16x32_bf16 v[224:227], v[52:55], v[132:135], v[224:227]
    s_waitcnt lgkmcnt(13)
    v_mfma_f32_16x16x32_bf16 v[224:227], v[56:59], v[136:139], v[224:227]
    s_waitcnt lgkmcnt(12)
    v_mfma_f32_16x16x32_bf16 v[224:227], v[60:63], v[140:143], v[224:227]
    s_waitcnt lgkmcnt(11)
    v_mfma_f32_16x16x32_bf16 v[224:227], v[64:67], v[144:147], v[224:227]
    s_waitcnt lgkmcnt(10)
    v_mfma_f32_16x16x32_bf16 v[224:227], v[68:71], v[148:151], v[224:227]
    s_waitcnt lgkmcnt(9)
    v_mfma_f32_16x16x32_bf16 v[224:227], v[72:75], v[152:155], v[224:227]
    s_waitcnt lgkmcnt(8)
    v_mfma_f32_16x16x32_bf16 v[224:227], v[76:79], v[156:159], v[224:227]
    s_waitcnt lgkmcnt(7)
    v_mfma_f32_16x16x32_bf16 v[224:227], v[80:83], v[160:163], v[224:227]
    s_waitcnt lgkmcnt(6)
    v_mfma_f32_16x16x32_bf16 v[224:227], v[84:87], v[164:167], v[224:227]
    s_waitcnt lgkmcnt(5)
    v_mfma_f32_16x16x32_bf16 v[224:227], v[88:91], v[168:171], v[224:227]
    s_waitcnt lgkmcnt(4)
    v_mfma_f32_16x16x32_bf16 v[224:227], v[92:95], v[172:175], v[224:227]
    s_waitcnt lgkmcnt(3)
    v_mfma_f32_16x16x32_bf16 v[224:227], v[96:99], v[176:179], v[224:227]
    s_waitcnt lgkmcnt(2)
    v_mfma_f32_16x16x32_bf16 v[224:227], v[100:103], v[180:183], v[224:227]
    s_waitcnt lgkmcnt(1)
    v_mfma_f32_16x16x32_bf16 v[224:227], v[104:107], v[184:187], v[224:227]
    s_waitcnt lgkmcnt(0)
    v_mfma_f32_16x16x32_bf16 v[224:227], v[108:111], v[188:191], v[224:227]
    s_waitcnt vmcnt(0)
    v_min_u32 v2, v4, v5
    v_cmp_eq_u32 vcc, 0, v2
    s_cbranch_vccnz L_nl_20
L_nd_21:
    s_nop 7
    v_cvt_pk_bf16_f32 v2, v224, v224
    v_lshlrev_b32 v2, 16, v2
    v_mul_f32 v2, 0xbfb8aa3b, v2
    v_exp_f32 v2, v2
    s_nop 0
    v_add_f32 v2, 1.0, v2
    v_rcp_f32 v2, v2
    s_nop 0
    v_cvt_pk_bf16_f32 v2, v2, v2
    v_lshlrev_b32 v2, 16, v2
    s_lshl_b32 s78, s76, 2
    s_add_u32 s9, s78, 16515072
    s_add_u32 s78, s78, 15728640
    v_lshlrev_b32 v3, 2, v1
    buffer_load_dwordx2 v[6:7], v10, s[60:63], 0 offen sc1
    s_mul_i32 s81, s5, 54
    s_add_u32 s81, s81, s6
    s_mul_i32 s81, s81, 5120
    s_add_u32 s81, s81, 20971520
    s_mul_i32 s84, s3, 25600
    s_cmp_ge_u32 s3, 2
    s_cselect_b32 s95, 13, 14
    s_mul_i32 s94, s5, 13
    s_lshr_b32 s94, s94, 3
    s_lshr_b32 s85, s4, 2
    s_mul_i32 s85, s85, 13
    s_lshr_b32 s85, s85, 3
    s_add_u32 s94, s94, s85
    s_cmp_ge_u32 s94, s95
    s_cselect_b32 s85, s95, 0
    s_sub_u32 s94, s94, s85
    s_mov_b32 s14, 0
    s_waitcnt vmcnt(0)
    s_mov_b64 exec, 0xffff
    buffer_store_dword v2, v3, s[60:63], s78 offen sc1
    s_mov_b64 exec, -1
    s_branch L_g2
L_load:
    s_setprio 3
    s_mov_b32 s56, s38
    s_mov_b32 s57, s39
    s_mov_b32 s58, 0x21c000
    s_mov_b32 s59, 0x00020000
    s_sub_u32 s5, s2, 160
    s_lshl_b32 s5, s5, 2
    s_add_u32 s5, s5, s3
    s_lshl_b32 s12, s3, 13
    s_add_u32 s12, s12, 106496
    v_lshrrev_b32 v2, 3, v1
    v_mul_u32_u24 v2, 1280, v2
    v_and_b32 v3, 7, v1
    v_lshl_add_u32 v2, v3, 4, v2
    s_mul_i32 s6, s5, 6554
    s_lshr_b32 s6, s6, 16
    s_mul_i32 s7, s6, 10
    s_sub_u32 s7, s5, s7
    s_mul_i32 s10, s6, 40960
    s_lshl_b32 s11, s7, 7
    s_add_u32 s10, s10, s11
    s_add_u32 m0, s12, 0
    s_add_u32 s11, s10, 0
    buffer_load_dwordx4 v2, s[56:59], s11 offen lds
    s_add_u32 m0, s12, 1024
    s_add_u32 s11, s10, 10240
    buffer_load_dwordx4 v2, s[56:59], s11 offen lds
    s_add_u32 m0, s12, 2048
    s_add_u32 s11, s10, 20480
    buffer_load_dwordx4 v2, s[56:59], s11 offen lds
    s_add_u32 m0, s12, 3072
    s_add_u32 s11, s10, 30720
    buffer_load_dwordx4 v2, s[56:59], s11 offen lds
    s_add_u32 s5, s5, 156
    s_cmp_lt_u32 s5, 384
    s_cselect_b32 s5, 600, s5
    s_mul_i32 s8, s5, 6554
    s_lshr_b32 s8, s8, 16
    s_mul_i32 s9, s8, 10
    s_sub_u32 s9, s5, s9
    s_cmp_ge_u32 s5, 540
    s_cbranch_scc1 L_ld1
    s_mul_i32 s10, s8, 40960
    s_lshl_b32 s11, s9, 7
    s_add_u32 s10, s10, s11
    s_add_u32 m0, s12, 4096
    s_add_u32 s11, s10, 0
    buffer_load_dwordx4 v2, s[56:59], s11 offen lds
    s_add_u32 m0, s12, 5120
    s_add_u32 s11, s10, 10240
    buffer_load_dwordx4 v2, s[56:59], s11 offen lds
    s_add_u32 m0, s12, 6144
    s_add_u32 s11, s10, 20480
    buffer_load_dwordx4 v2, s[56:59], s11 offen lds
    s_add_u32 m0, s12, 7168
    s_add_u32 s11, s10, 30720
    buffer_load_dwordx4 v2, s[56:59], s11 offen lds
L_ld1:
    v_mov_b32 v8, 0
    v_lshlrev_b32 v9, 4, v1
    v_lshrrev_b32 v2, 5, v1
    v_lshlrev_b32 v2, 4, v2
    v_bfe_u32 v3, v1, 2, 3
    v_add_u32 v2, v2, v3
    v_lshlrev_b32 v2, 7, v2
    v_and_b32 v3, 3, v1
    v_lshl_add_u32 v2, v3, 3, v2
    v_add_u32 v12, s12, v2
    s_cmp_ge_u32 s5, 540
    s_cselect_b32 s10, 0x7f000000, 0
    v_add_u32 v13, s10, v9
    s_cselect_b32 s8, 63, s8
    s_cselect_b32 s9, 0, s9
    s_waitcnt vmcnt(0)
    ds_read_b64_tr_b16 v[16:17], v12 offset:0
    ds_read_b64_tr_b16 v[18:19], v12 offset:1024
    ds_read_b64_tr_b16 v[20:21], v12 offset:32
    ds_read_b64_tr_b16 v[22:23], v12 offset:1056
    ds_read_b64_tr_b16 v[24:25], v12 offset:64
    ds_read_b64_tr_b16 v[26:27], v12 offset:1088
    ds_read_b64_tr_b16 v[28:29], v12 offset:96
    ds_read_b64_tr_b16 v[30:31], v12 offset:1120
    ds_read_b64_tr_b16 v[32:33], v12 offset:4096
    ds_read_b64_tr_b16 v[34:35], v12 offset:5120
    ds_read_b64_tr_b16 v[36:37], v12 offset:4128
    ds_read_b64_tr_b16 v[38:39], v12 offset:5152
    ds_read_b64_tr_b16 v[40:41], v12 offset:4160
    ds_read_b64_tr_b16 v[42:43], v12 offset:5184
    ds_read_b64_tr_b16 v[44:45], v12 offset:4192
    ds_read_b64_tr_b16 v[46:47], v12 offset:5216
    s_lshl_b32 s14, s7, 2
    s_add_u32 s14, s14, 0
    s_mul_i32 s15, s14, 205
    s_lshr_b32 s15, s15, 10
    s_mul_i32 s15, s15, 265
    s_add_u32 s14, s14, s15
    s_mul_i32 s15, s6, 5
    s_add_u32 s14, s14, s15
    s_lshl_b32 s14, s14, 10
    s_add_u32 s14, s14, 20971520
    s_waitcnt lgkmcnt(8)
    s_setprio 3
    buffer_store_dwordx4 v[16:19], v9, s[60:63], s14 offen sc1
    s_setprio 0
    s_lshl_b32 s14, s7, 2
    s_add_u32 s14, s14, 1
    s_mul_i32 s15, s14, 205
    s_lshr_b32 s15, s15, 10
    s_mul_i32 s15, s15, 265
    s_add_u32 s14, s14, s15
    s_mul_i32 s15, s6, 5
    s_add_u32 s14, s14, s15
    s_lshl_b32 s14, s14, 10
    s_add_u32 s14, s14, 20971520
    s_setprio 3
    buffer_store_dwordx4 v[20:23], v9, s[60:63], s14 offen sc1
    s_setprio 0
    s_lshl_b32 s14, s7, 2
    s_add_u32 s14, s14, 2
    s_mul_i32 s15, s14, 205
    s_lshr_b32 s15, s15, 10
    s_mul_i32 s15, s15, 265
    s_add_u32 s14, s14, s15
    s_mul_i32 s15, s6, 5
    s_add_u32 s14, s14, s15
    s_lshl_b32 s14, s14, 10
    s_add_u32 s14, s14, 20971520
    s_setprio 3
    buffer_store_dwordx4 v[24:27], v9, s[60:63], s14 offen sc1
    s_setprio 0
    s_lshl_b32 s14, s7, 2
    s_add_u32 s14, s14, 3
    s_mul_i32 s15, s14, 205
    s_lshr_b32 s15, s15, 10
    s_mul_i32 s15, s15, 265
    s_add_u32 s14, s14, s15
    s_mul_i32 s15, s6, 5
    s_add_u32 s14, s14, s15
    s_lshl_b32 s14, s14, 10
    s_add_u32 s14, s14, 20971520
    s_setprio 3
    buffer_store_dwordx4 v[28:31], v9, s[60:63], s14 offen sc1
    s_setprio 0
    s_lshl_b32 s14, s9, 2
    s_add_u32 s14, s14, 0
    s_mul_i32 s15, s14, 205
    s_lshr_b32 s15, s15, 10
    s_mul_i32 s15, s15, 265
    s_add_u32 s14, s14, s15
    s_mul_i32 s15, s8, 5
    s_add_u32 s14, s14, s15
    s_lshl_b32 s14, s14, 10
    s_add_u32 s14, s14, 20971520
    s_waitcnt lgkmcnt(0)
    s_setprio 3
    buffer_store_dwordx4 v[32:35], v13, s[60:63], s14 offen sc1
    s_setprio 0
    s_lshl_b32 s14, s9, 2
    s_add_u32 s14, s14, 1
    s_mul_i32 s15, s14, 205
    s_lshr_b32 s15, s15, 10
    s_mul_i32 s15, s15, 265
    s_add_u32 s14, s14, s15
    s_mul_i32 s15, s8, 5
    s_add_u32 s14, s14, s15
    s_lshl_b32 s14, s14, 10
    s_add_u32 s14, s14, 20971520
    s_setprio 3
    buffer_store_dwordx4 v[36:39], v13, s[60:63], s14 offen sc1
    s_setprio 0
    s_lshl_b32 s14, s9, 2
    s_add_u32 s14, s14, 2
    s_mul_i32 s15, s14, 205
    s_lshr_b32 s15, s15, 10
    s_mul_i32 s15, s15, 265
    s_add_u32 s14, s14, s15
    s_mul_i32 s15, s8, 5
    s_add_u32 s14, s14, s15
    s_lshl_b32 s14, s14, 10
    s_add_u32 s14, s14, 20971520
    s_setprio 3
    buffer_store_dwordx4 v[40:43], v13, s[60:63], s14 offen sc1
    s_setprio 0
    s_lshl_b32 s14, s9, 2
    s_add_u32 s14, s14, 3
    s_mul_i32 s15, s14, 205
    s_lshr_b32 s15, s15, 10
    s_mul_i32 s15, s15, 265
    s_add_u32 s14, s14, s15
    s_mul_i32 s15, s8, 5
    s_add_u32 s14, s14, s15
    s_lshl_b32 s14, s14, 10
    s_add_u32 s14, s14, 20971520
    s_setprio 3
    buffer_store_dwordx4 v[44:47], v13, s[60:63], s14 offen sc1
    buffer_load_dwordx2 v[4:5], v8, s[72:75], 0 offen sc1
    s_setprio 0
    s_cmp_lt_u32 s2, 224
    s_cbranch_scc1 L_ldp
    s_barrier
L_ldp:
    s_cmp_ge_u32 s2, 224
    s_cbranch_scc1 L_lb_23
    s_barrier
    s_barrier
    s_barrier
L_lb_23:
    s_waitcnt vmcnt(0)
    v_min_u32 v2, v4, v5
    v_cmp_eq_u32 vcc, 0, v2
    s_cbranch_vccnz L_nl_24
L_nd_25:
    s_lshl_b32 s14, s7, 6
    s_add_u32 s14, s14, s6
    s_lshl_b32 s14, s14, 6
    s_add_u32 s14, s14, 16318464
    s_mov_b64 exec, 1
    s_setprio 3
    buffer_store_dwordx2 v[4:5], v8, s[60:63], s14 offen sc1
    s_setprio 0
    s_mov_b64 exec, -1
    s_cmp_ge_u32 s5, 540
    s_cbranch_scc1 L_ld3
    s_lshl_b32 s14, s9, 6
    s_add_u32 s14, s14, s8
    s_lshl_b32 s14, s14, 6
    s_add_u32 s14, s14, 16318464
    s_mov_b64 exec, 1
    s_setprio 3
    buffer_store_dwordx2 v[4:5], v8, s[60:63], s14 offen sc1
    s_setprio 0
    s_mov_b64 exec, -1
L_ld3:
    s_cmp_ge_u32 s2, 224
    s_cbranch_scc1 L_lb_27
    s_barrier
    s_barrier
    s_barrier
    s_barrier
    s_barrier
    s_barrier
    s_barrier
    s_barrier
    s_barrier
    s_barrier
    s_barrier
    s_barrier
    s_barrier
    s_barrier
    s_barrier
    s_barrier
    s_barrier
    s_barrier
L_lb_27:
L_ldx:
    s_endpgm
L_nl_14:
    s_mov_b32 s87, 0
L_nm_16:
    s_sleep 4
    buffer_load_dwordx2 v[4:5], v8, s[72:75], 0 offen sc1
    s_waitcnt vmcnt(0)
    v_min_u32 v2, v4, v5
    v_cmp_eq_u32 vcc, 0, v2
    s_cbranch_vccz L_nd_15
    s_add_u32 s87, s87, 1
    s_cmp_lt_u32 s87, 0x8000
    s_cbranch_scc1 L_nm_16
    s_branch L_nd_15
L_fl_17:
    s_mov_b32 s87, 0
L_fm_19:
    buffer_load_dwordx2 v[6:7], v10, s[60:63], 0 offen sc1
    s_waitcnt vmcnt(0)
    v_cmp_eq_u64 vcc, v[4:5], v[6:7]
    s_nop 0
    s_cmp_eq_u64 vcc, -1
    s_cbranch_scc1 L_fd_18
    s_sleep 8
    s_add_u32 s87, s87, 1
    s_cmp_lt_u32 s87, 0x8000
    s_cbranch_scc1 L_fm_19
    s_branch L_fd_18
L_nl_20:
    s_mov_b32 s87, 0
L_nm_22:
    s_sleep 4
    buffer_load_dwordx2 v[4:5], v8, s[72:75], 0 offen sc1
    s_waitcnt vmcnt(0)
    v_min_u32 v2, v4, v5
    v_cmp_eq_u32 vcc, 0, v2
    s_cbranch_vccz L_nd_21
    s_add_u32 s87, s87, 1
    s_cmp_lt_u32 s87, 0x8000
    s_cbranch_scc1 L_nm_22
    s_branch L_nd_21
L_nl_24:
    s_mov_b32 s87, 0
L_nm_26:
    s_sleep 4
    buffer_load_dwordx2 v[4:5], v8, s[72:75], 0 offen sc1
    s_waitcnt vmcnt(0)
    v_min_u32 v2, v4, v5
    v_cmp_eq_u32 vcc, 0, v2
    s_cbranch_vccz L_nd_25
    s_add_u32 s87, s87, 1
    s_cmp_lt_u32 s87, 0x8000
    s_cbranch_scc1 L_nm_26
    s_branch L_nd_25
L_code_end:
.section .rodata,"a"
.p2align 6
.amdhsa_kernel gated_mix__ssm_conv_s4__dense_activation_relu__prompt_kernel
.amdhsa_next_free_vgpr 256
.amdhsa_next_free_sgpr 102
.amdhsa_accum_offset 256
.amdhsa_group_segment_fixed_size 0
.amdhsa_kernarg_size 128
.amdhsa_user_sgpr_count 2
.amdhsa_user_sgpr_kernarg_segment_ptr 1
.amdhsa_system_sgpr_workgroup_id_x 1
.end_amdhsa_kernel
```
